```python
import torch

def _softmax(x, axis=-1):
    return torch.softmax(x, dim=axis)
def _gelu(x):
    return torch.nn.functional.gelu(x, approximate="tanh")
def _silu(x):
    return torch.nn.functional.silu(x)
def _sigmoid(x):
    return torch.sigmoid(x)
def _layernorm(x, axis=-1, eps=1e-5):
    m = x.mean(dim=axis, keepdim=True)
    v = x.var(dim=axis, keepdim=True, unbiased=False)
    return (x - m) / torch.sqrt(v + eps)
def _scatter_add(tgt, idx, src, axis=0):
    return tgt.clone().index_add_(axis, idx, src)
def _segment_sum(src, seg, n):
    out = torch.zeros((n,) + src.shape[1:], dtype=src.dtype)
    return out.index_add_(0, seg, src)
def _pad(x, pw):
    flat = tuple(v for pair in reversed(pw) for v in pair)
    return torch.nn.functional.pad(x, flat)

kernel_name = 'concat_heads__mha_block__softmax_full_mha__prompt'

def setup_inputs():

    _w = (lambda a: (lambda t: t.to(torch.bfloat16) if t.is_floating_point() else t)(torch.as_tensor(a)))
    def _A_setup():
        B, S, D, H = 1, 2048, 448, 16
        return {
            "x": _w((lambda *s: torch.randn(*s, dtype=torch.bfloat16) * 0.2)(B, S, D)),
            "wqkv": _w((lambda *s: torch.randn(*s, dtype=torch.bfloat16) * 0.2)(D, 3 * D)),
            "wo": _w((lambda *s: torch.randn(*s, dtype=torch.bfloat16) * 0.05)(D, D)),
        }
    _A_in = _A_setup()

    def _B_setup():
        B, S, D = 1, 2048, 448
        return {
            "x": _w((lambda *s: torch.randn(*s, dtype=torch.bfloat16) * 0.2)(B, S, D)),
            "wqkv": _w((lambda *s: torch.randn(*s, dtype=torch.bfloat16) * 0.2)(D, 3 * D)),
            "wo": _w((lambda *s: torch.randn(*s, dtype=torch.bfloat16) * 0.05)(D, D)),
        }
    _B_in = _B_setup()

    return {
        "A_x": _A_in["x"],
        "A_wqkv": _A_in["wqkv"],
        "A_wo": _A_in["wo"],
        "B_x": _B_in["x"],
        "B_wqkv": _B_in["wqkv"],
        "B_wo": _B_in["wo"],
    }

def reference(A_x, A_wqkv, A_wo, B_x, B_wqkv, B_wo):
    def _A_ref(x, wqkv, wo):
        B, S, D = x.shape
        H = 16
        Dh = D // H
        qkv = (lambda x, *d: x.permute(*d))((x @ wqkv).reshape(B, S, 3, H, Dh), 2, 0, 3, 1, 4)
        q, k, v = qkv[0], qkv[1], qkv[2]
        scores = torch.einsum("bhqd,bhkd->bhqk", q, k) * (Dh ** -0.5)
        p = _softmax(scores, axis=-1)
        o = torch.einsum("bhqk,bhkd->bhqd", p, v)
        return (lambda x, *d: x.permute(*d))(o, 0, 2, 1, 3).reshape(B, S, D) @ wo

    def _B_ref(x, wqkv, wo):
        B, S, D = x.shape
        H = 16; Dh = D // H
        qkv = (lambda x, *d: x.permute(*d))((x @ wqkv).reshape(B, S, 3, H, Dh), 2, 0, 3, 1, 4)
        q, k, v = qkv[0], qkv[1], qkv[2]
        scale = Dh ** -0.5
        scores = torch.einsum("bhqd,bhkd->bhqk", q, k) * scale
        p = _softmax(scores, axis=-1)
        o = torch.einsum("bhqk,bhkd->bhqd", p, v)
        return (lambda x, *d: x.permute(*d))(o, 0, 2, 1, 3).reshape(B, S, D) @ wo

    a = _A_ref(A_x, A_wqkv, A_wo)
    b = _B_ref(B_x, B_wqkv, B_wo)
    return torch.concatenate([a, b], axis=-1)
```

```asm
; @launch kernel=qkv_kernel grid=(672,1,1) block=(256,1,1) lds=57344
; @launch kernel=attn_kernel grid=(512,1,1) block=(256,1,1) lds=32768
; @launch kernel=oproj_kernel grid=(224,1,1) block=(256,1,1) lds=57344
.amdgcn_target "amdgcn-amd-amdhsa--gfx950"
.text
.globl qkv_kernel
.p2align 8
.type qkv_kernel,@function
qkv_kernel:
s_cmp_ge_u32 s2, 672
s_cbranch_scc1 qkv_kernel_end
s_load_dwordx8 s[4:11], s[0:1], 0
s_load_dwordx8 s[12:19], s[0:1], 32
s_load_dwordx2 s[20:21], s[0:1], 64
s_mov_b32 s22, 204522253
s_mul_hi_u32 s23, s2, s22
s_mul_i32 s24, s23, 21
s_sub_u32 s24, s2, s24
s_and_b32 s25, s23, 15
s_lshr_b32 s26, s23, 4
v_lshrrev_b32 v1, 6, v0
v_and_b32 v2, 63, v0
s_nop 0
v_readfirstlane_b32 s27, v1
s_waitcnt lgkmcnt(0)
s_cmp_eq_u32 s26, 0
s_cselect_b32 s28, s4, s10
s_cselect_b32 s29, s5, s11
s_cselect_b32 s30, s6, s12
s_cselect_b32 s31, s7, s13
s_lshl_b32 s33, s24, 6
s_mul_i32 s34, s27, 112
v_lshrrev_b32 v3, 3, v2
v_add_u32 v3, s34, v3
v_and_b32 v4, 7, v2
s_mov_b32 s35, 2688
v_mul_lo_u32 v5, v3, s35
s_lshl_b32 s36, s33, 1
v_lshlrev_b32 v6, 4, v4
v_add3_u32 v5, v5, v6, s36
v_lshrrev_b32 v6, 2, v4
v_mul_u32_u24 v6, 28672, v6
v_lshlrev_b32 v7, 6, v3
v_and_b32 v8, 3, v2
v_lshlrev_b32 v8, 4, v8
v_add3_u32 v6, v6, v7, v8
global_load_dwordx4 v[128:131], v5, s[30:31]
v_add_u32 v5, 21504, v5
global_load_dwordx4 v[132:135], v5, s[30:31]
v_add_u32 v5, 21504, v5
global_load_dwordx4 v[136:139], v5, s[30:31]
v_add_u32 v5, 21504, v5
global_load_dwordx4 v[140:143], v5, s[30:31]
v_add_u32 v5, 21504, v5
global_load_dwordx4 v[144:147], v5, s[30:31]
v_add_u32 v5, 21504, v5
global_load_dwordx4 v[148:151], v5, s[30:31]
v_add_u32 v5, 21504, v5
global_load_dwordx4 v[152:155], v5, s[30:31]
v_add_u32 v5, 21504, v5
global_load_dwordx4 v[156:159], v5, s[30:31]
v_add_u32 v5, 21504, v5
global_load_dwordx4 v[160:163], v5, s[30:31]
v_add_u32 v5, 21504, v5
global_load_dwordx4 v[164:167], v5, s[30:31]
v_add_u32 v5, 21504, v5
global_load_dwordx4 v[168:171], v5, s[30:31]
v_add_u32 v5, 21504, v5
global_load_dwordx4 v[172:175], v5, s[30:31]
v_add_u32 v5, 21504, v5
global_load_dwordx4 v[176:179], v5, s[30:31]
v_add_u32 v5, 21504, v5
global_load_dwordx4 v[180:183], v5, s[30:31]
s_lshl_b32 s37, s25, 7
s_lshl_b32 s38, s27, 5
s_add_u32 s37, s37, s38
v_and_b32 v9, 31, v2
v_add_u32 v10, s37, v9
v_mul_u32_u24 v10, 896, v10
v_lshrrev_b32 v11, 5, v2
v_lshlrev_b32 v12, 4, v11
v_add_u32 v10, v10, v12
global_load_dwordx4 v[16:19], v10, s[28:29] offset:0
global_load_dwordx4 v[20:23], v10, s[28:29] offset:32
global_load_dwordx4 v[24:27], v10, s[28:29] offset:64
global_load_dwordx4 v[28:31], v10, s[28:29] offset:96
global_load_dwordx4 v[32:35], v10, s[28:29] offset:128
global_load_dwordx4 v[36:39], v10, s[28:29] offset:160
global_load_dwordx4 v[40:43], v10, s[28:29] offset:192
global_load_dwordx4 v[44:47], v10, s[28:29] offset:224
global_load_dwordx4 v[48:51], v10, s[28:29] offset:256
global_load_dwordx4 v[52:55], v10, s[28:29] offset:288
global_load_dwordx4 v[56:59], v10, s[28:29] offset:320
global_load_dwordx4 v[60:63], v10, s[28:29] offset:352
global_load_dwordx4 v[64:67], v10, s[28:29] offset:384
global_load_dwordx4 v[68:71], v10, s[28:29] offset:416
global_load_dwordx4 v[72:75], v10, s[28:29] offset:448
global_load_dwordx4 v[76:79], v10, s[28:29] offset:480
global_load_dwordx4 v[80:83], v10, s[28:29] offset:512
global_load_dwordx4 v[84:87], v10, s[28:29] offset:544
global_load_dwordx4 v[88:91], v10, s[28:29] offset:576
global_load_dwordx4 v[92:95], v10, s[28:29] offset:608
global_load_dwordx4 v[96:99], v10, s[28:29] offset:640
global_load_dwordx4 v[100:103], v10, s[28:29] offset:672
global_load_dwordx4 v[104:107], v10, s[28:29] offset:704
global_load_dwordx4 v[108:111], v10, s[28:29] offset:736
global_load_dwordx4 v[112:115], v10, s[28:29] offset:768
global_load_dwordx4 v[116:119], v10, s[28:29] offset:800
global_load_dwordx4 v[120:123], v10, s[28:29] offset:832
global_load_dwordx4 v[124:127], v10, s[28:29] offset:864
s_waitcnt vmcnt(28)
ds_write_b128 v6, v[128:131] offset:0
ds_write_b128 v6, v[132:135] offset:512
ds_write_b128 v6, v[136:139] offset:1024
ds_write_b128 v6, v[140:143] offset:1536
ds_write_b128 v6, v[144:147] offset:2048
ds_write_b128 v6, v[148:151] offset:2560
ds_write_b128 v6, v[152:155] offset:3072
ds_write_b128 v6, v[156:159] offset:3584
ds_write_b128 v6, v[160:163] offset:4096
ds_write_b128 v6, v[164:167] offset:4608
ds_write_b128 v6, v[168:171] offset:5120
ds_write_b128 v6, v[172:175] offset:5632
ds_write_b128 v6, v[176:179] offset:6144
ds_write_b128 v6, v[180:183] offset:6656
v_lshrrev_b32 v13, 4, v2
v_lshrrev_b32 v14, 1, v13
v_lshlrev_b32 v14, 9, v14
v_and_b32 v15, 15, v2
v_lshrrev_b32 v15, 2, v15
v_lshlrev_b32 v15, 6, v15
v_add_u32 v14, v14, v15
v_and_b32 v13, 1, v13
v_lshlrev_b32 v13, 5, v13
v_and_b32 v15, 3, v2
v_lshlrev_b32 v15, 3, v15
v_add3_u32 v14, v14, v13, v15
s_waitcnt lgkmcnt(0)
s_barrier
v_mov_b32 v192, 0
v_mov_b32 v193, 0
v_mov_b32 v194, 0
v_mov_b32 v195, 0
v_mov_b32 v196, 0
v_mov_b32 v197, 0
v_mov_b32 v198, 0
v_mov_b32 v199, 0
v_mov_b32 v200, 0
v_mov_b32 v201, 0
v_mov_b32 v202, 0
v_mov_b32 v203, 0
v_mov_b32 v204, 0
v_mov_b32 v205, 0
v_mov_b32 v206, 0
v_mov_b32 v207, 0
v_mov_b32 v208, 0
v_mov_b32 v209, 0
v_mov_b32 v210, 0
v_mov_b32 v211, 0
v_mov_b32 v212, 0
v_mov_b32 v213, 0
v_mov_b32 v214, 0
v_mov_b32 v215, 0
v_mov_b32 v216, 0
v_mov_b32 v217, 0
v_mov_b32 v218, 0
v_mov_b32 v219, 0
v_mov_b32 v220, 0
v_mov_b32 v221, 0
v_mov_b32 v222, 0
v_mov_b32 v223, 0
s_cmp_ge_u32 s24, 14
s_cbranch_scc1 qkv_kernel_v
ds_read_b64_tr_b16 v[224:225], v14 offset:0
ds_read_b64_tr_b16 v[226:227], v14 offset:256
ds_read_b64_tr_b16 v[228:229], v14 offset:28672
ds_read_b64_tr_b16 v[230:231], v14 offset:28928
ds_read_b64_tr_b16 v[240:241], v14 offset:1024
ds_read_b64_tr_b16 v[242:243], v14 offset:1280
ds_read_b64_tr_b16 v[244:245], v14 offset:29696
ds_read_b64_tr_b16 v[246:247], v14 offset:29952
s_waitcnt vmcnt(27) lgkmcnt(4)
v_mfma_f32_32x32x16_bf16 v[192:207], v[224:227], v[16:19], v[192:207]
v_mfma_f32_32x32x16_bf16 v[208:223], v[228:231], v[16:19], v[208:223]
ds_read_b64_tr_b16 v[224:225], v14 offset:2048
ds_read_b64_tr_b16 v[226:227], v14 offset:2304
ds_read_b64_tr_b16 v[228:229], v14 offset:30720
ds_read_b64_tr_b16 v[230:231], v14 offset:30976
s_waitcnt vmcnt(26) lgkmcnt(4)
v_mfma_f32_32x32x16_bf16 v[192:207], v[240:243], v[20:23], v[192:207]
v_mfma_f32_32x32x16_bf16 v[208:223], v[244:247], v[20:23], v[208:223]
ds_read_b64_tr_b16 v[240:241], v14 offset:3072
ds_read_b64_tr_b16 v[242:243], v14 offset:3328
ds_read_b64_tr_b16 v[244:245], v14 offset:31744
ds_read_b64_tr_b16 v[246:247], v14 offset:32000
s_waitcnt vmcnt(25) lgkmcnt(4)
v_mfma_f32_32x32x16_bf16 v[192:207], v[224:227], v[24:27], v[192:207]
v_mfma_f32_32x32x16_bf16 v[208:223], v[228:231], v[24:27], v[208:223]
ds_read_b64_tr_b16 v[224:225], v14 offset:4096
ds_read_b64_tr_b16 v[226:227], v14 offset:4352
ds_read_b64_tr_b16 v[228:229], v14 offset:32768
ds_read_b64_tr_b16 v[230:231], v14 offset:33024
s_waitcnt vmcnt(24) lgkmcnt(4)
v_mfma_f32_32x32x16_bf16 v[192:207], v[240:243], v[28:31], v[192:207]
v_mfma_f32_32x32x16_bf16 v[208:223], v[244:247], v[28:31], v[208:223]
ds_read_b64_tr_b16 v[240:241], v14 offset:5120
ds_read_b64_tr_b16 v[242:243], v14 offset:5376
ds_read_b64_tr_b16 v[244:245], v14 offset:33792
ds_read_b64_tr_b16 v[246:247], v14 offset:34048
s_waitcnt vmcnt(23) lgkmcnt(4)
v_mfma_f32_32x32x16_bf16 v[192:207], v[224:227], v[32:35], v[192:207]
v_mfma_f32_32x32x16_bf16 v[208:223], v[228:231], v[32:35], v[208:223]
ds_read_b64_tr_b16 v[224:225], v14 offset:6144
ds_read_b64_tr_b16 v[226:227], v14 offset:6400
ds_read_b64_tr_b16 v[228:229], v14 offset:34816
ds_read_b64_tr_b16 v[230:231], v14 offset:35072
s_waitcnt vmcnt(22) lgkmcnt(4)
v_mfma_f32_32x32x16_bf16 v[192:207], v[240:243], v[36:39], v[192:207]
v_mfma_f32_32x32x16_bf16 v[208:223], v[244:247], v[36:39], v[208:223]
ds_read_b64_tr_b16 v[240:241], v14 offset:7168
ds_read_b64_tr_b16 v[242:243], v14 offset:7424
ds_read_b64_tr_b16 v[244:245], v14 offset:35840
ds_read_b64_tr_b16 v[246:247], v14 offset:36096
s_waitcnt vmcnt(21) lgkmcnt(4)
v_mfma_f32_32x32x16_bf16 v[192:207], v[224:227], v[40:43], v[192:207]
v_mfma_f32_32x32x16_bf16 v[208:223], v[228:231], v[40:43], v[208:223]
ds_read_b64_tr_b16 v[224:225], v14 offset:8192
ds_read_b64_tr_b16 v[226:227], v14 offset:8448
ds_read_b64_tr_b16 v[228:229], v14 offset:36864
ds_read_b64_tr_b16 v[230:231], v14 offset:37120
s_waitcnt vmcnt(20) lgkmcnt(4)
v_mfma_f32_32x32x16_bf16 v[192:207], v[240:243], v[44:47], v[192:207]
v_mfma_f32_32x32x16_bf16 v[208:223], v[244:247], v[44:47], v[208:223]
ds_read_b64_tr_b16 v[240:241], v14 offset:9216
ds_read_b64_tr_b16 v[242:243], v14 offset:9472
ds_read_b64_tr_b16 v[244:245], v14 offset:37888
ds_read_b64_tr_b16 v[246:247], v14 offset:38144
s_waitcnt vmcnt(19) lgkmcnt(4)
v_mfma_f32_32x32x16_bf16 v[192:207], v[224:227], v[48:51], v[192:207]
v_mfma_f32_32x32x16_bf16 v[208:223], v[228:231], v[48:51], v[208:223]
ds_read_b64_tr_b16 v[224:225], v14 offset:10240
ds_read_b64_tr_b16 v[226:227], v14 offset:10496
ds_read_b64_tr_b16 v[228:229], v14 offset:38912
ds_read_b64_tr_b16 v[230:231], v14 offset:39168
s_waitcnt vmcnt(18) lgkmcnt(4)
v_mfma_f32_32x32x16_bf16 v[192:207], v[240:243], v[52:55], v[192:207]
v_mfma_f32_32x32x16_bf16 v[208:223], v[244:247], v[52:55], v[208:223]
ds_read_b64_tr_b16 v[240:241], v14 offset:11264
ds_read_b64_tr_b16 v[242:243], v14 offset:11520
ds_read_b64_tr_b16 v[244:245], v14 offset:39936
ds_read_b64_tr_b16 v[246:247], v14 offset:40192
s_waitcnt vmcnt(17) lgkmcnt(4)
v_mfma_f32_32x32x16_bf16 v[192:207], v[224:227], v[56:59], v[192:207]
v_mfma_f32_32x32x16_bf16 v[208:223], v[228:231], v[56:59], v[208:223]
ds_read_b64_tr_b16 v[224:225], v14 offset:12288
ds_read_b64_tr_b16 v[226:227], v14 offset:12544
ds_read_b64_tr_b16 v[228:229], v14 offset:40960
ds_read_b64_tr_b16 v[230:231], v14 offset:41216
s_waitcnt vmcnt(16) lgkmcnt(4)
v_mfma_f32_32x32x16_bf16 v[192:207], v[240:243], v[60:63], v[192:207]
v_mfma_f32_32x32x16_bf16 v[208:223], v[244:247], v[60:63], v[208:223]
ds_read_b64_tr_b16 v[240:241], v14 offset:13312
ds_read_b64_tr_b16 v[242:243], v14 offset:13568
ds_read_b64_tr_b16 v[244:245], v14 offset:41984
ds_read_b64_tr_b16 v[246:247], v14 offset:42240
s_waitcnt vmcnt(15) lgkmcnt(4)
v_mfma_f32_32x32x16_bf16 v[192:207], v[224:227], v[64:67], v[192:207]
v_mfma_f32_32x32x16_bf16 v[208:223], v[228:231], v[64:67], v[208:223]
ds_read_b64_tr_b16 v[224:225], v14 offset:14336
ds_read_b64_tr_b16 v[226:227], v14 offset:14592
ds_read_b64_tr_b16 v[228:229], v14 offset:43008
ds_read_b64_tr_b16 v[230:231], v14 offset:43264
s_waitcnt vmcnt(14) lgkmcnt(4)
v_mfma_f32_32x32x16_bf16 v[192:207], v[240:243], v[68:71], v[192:207]
v_mfma_f32_32x32x16_bf16 v[208:223], v[244:247], v[68:71], v[208:223]
ds_read_b64_tr_b16 v[240:241], v14 offset:15360
ds_read_b64_tr_b16 v[242:243], v14 offset:15616
ds_read_b64_tr_b16 v[244:245], v14 offset:44032
ds_read_b64_tr_b16 v[246:247], v14 offset:44288
s_waitcnt vmcnt(13) lgkmcnt(4)
v_mfma_f32_32x32x16_bf16 v[192:207], v[224:227], v[72:75], v[192:207]
v_mfma_f32_32x32x16_bf16 v[208:223], v[228:231], v[72:75], v[208:223]
ds_read_b64_tr_b16 v[224:225], v14 offset:16384
ds_read_b64_tr_b16 v[226:227], v14 offset:16640
ds_read_b64_tr_b16 v[228:229], v14 offset:45056
ds_read_b64_tr_b16 v[230:231], v14 offset:45312
s_waitcnt vmcnt(12) lgkmcnt(4)
v_mfma_f32_32x32x16_bf16 v[192:207], v[240:243], v[76:79], v[192:207]
v_mfma_f32_32x32x16_bf16 v[208:223], v[244:247], v[76:79], v[208:223]
ds_read_b64_tr_b16 v[240:241], v14 offset:17408
ds_read_b64_tr_b16 v[242:243], v14 offset:17664
ds_read_b64_tr_b16 v[244:245], v14 offset:46080
ds_read_b64_tr_b16 v[246:247], v14 offset:46336
s_waitcnt vmcnt(11) lgkmcnt(4)
v_mfma_f32_32x32x16_bf16 v[192:207], v[224:227], v[80:83], v[192:207]
v_mfma_f32_32x32x16_bf16 v[208:223], v[228:231], v[80:83], v[208:223]
ds_read_b64_tr_b16 v[224:225], v14 offset:18432
ds_read_b64_tr_b16 v[226:227], v14 offset:18688
ds_read_b64_tr_b16 v[228:229], v14 offset:47104
ds_read_b64_tr_b16 v[230:231], v14 offset:47360
s_waitcnt vmcnt(10) lgkmcnt(4)
v_mfma_f32_32x32x16_bf16 v[192:207], v[240:243], v[84:87], v[192:207]
v_mfma_f32_32x32x16_bf16 v[208:223], v[244:247], v[84:87], v[208:223]
ds_read_b64_tr_b16 v[240:241], v14 offset:19456
ds_read_b64_tr_b16 v[242:243], v14 offset:19712
ds_read_b64_tr_b16 v[244:245], v14 offset:48128
ds_read_b64_tr_b16 v[246:247], v14 offset:48384
s_waitcnt vmcnt(9) lgkmcnt(4)
v_mfma_f32_32x32x16_bf16 v[192:207], v[224:227], v[88:91], v[192:207]
v_mfma_f32_32x32x16_bf16 v[208:223], v[228:231], v[88:91], v[208:223]
ds_read_b64_tr_b16 v[224:225], v14 offset:20480
ds_read_b64_tr_b16 v[226:227], v14 offset:20736
ds_read_b64_tr_b16 v[228:229], v14 offset:49152
ds_read_b64_tr_b16 v[230:231], v14 offset:49408
s_waitcnt vmcnt(8) lgkmcnt(4)
v_mfma_f32_32x32x16_bf16 v[192:207], v[240:243], v[92:95], v[192:207]
v_mfma_f32_32x32x16_bf16 v[208:223], v[244:247], v[92:95], v[208:223]
ds_read_b64_tr_b16 v[240:241], v14 offset:21504
ds_read_b64_tr_b16 v[242:243], v14 offset:21760
ds_read_b64_tr_b16 v[244:245], v14 offset:50176
ds_read_b64_tr_b16 v[246:247], v14 offset:50432
s_waitcnt vmcnt(7) lgkmcnt(4)
v_mfma_f32_32x32x16_bf16 v[192:207], v[224:227], v[96:99], v[192:207]
v_mfma_f32_32x32x16_bf16 v[208:223], v[228:231], v[96:99], v[208:223]
ds_read_b64_tr_b16 v[224:225], v14 offset:22528
ds_read_b64_tr_b16 v[226:227], v14 offset:22784
ds_read_b64_tr_b16 v[228:229], v14 offset:51200
ds_read_b64_tr_b16 v[230:231], v14 offset:51456
s_waitcnt vmcnt(6) lgkmcnt(4)
v_mfma_f32_32x32x16_bf16 v[192:207], v[240:243], v[100:103], v[192:207]
v_mfma_f32_32x32x16_bf16 v[208:223], v[244:247], v[100:103], v[208:223]
ds_read_b64_tr_b16 v[240:241], v14 offset:23552
ds_read_b64_tr_b16 v[242:243], v14 offset:23808
ds_read_b64_tr_b16 v[244:245], v14 offset:52224
ds_read_b64_tr_b16 v[246:247], v14 offset:52480
s_waitcnt vmcnt(5) lgkmcnt(4)
v_mfma_f32_32x32x16_bf16 v[192:207], v[224:227], v[104:107], v[192:207]
v_mfma_f32_32x32x16_bf16 v[208:223], v[228:231], v[104:107], v[208:223]
ds_read_b64_tr_b16 v[224:225], v14 offset:24576
ds_read_b64_tr_b16 v[226:227], v14 offset:24832
ds_read_b64_tr_b16 v[228:229], v14 offset:53248
ds_read_b64_tr_b16 v[230:231], v14 offset:53504
s_waitcnt vmcnt(4) lgkmcnt(4)
v_mfma_f32_32x32x16_bf16 v[192:207], v[240:243], v[108:111], v[192:207]
v_mfma_f32_32x32x16_bf16 v[208:223], v[244:247], v[108:111], v[208:223]
ds_read_b64_tr_b16 v[240:241], v14 offset:25600
ds_read_b64_tr_b16 v[242:243], v14 offset:25856
ds_read_b64_tr_b16 v[244:245], v14 offset:54272
ds_read_b64_tr_b16 v[246:247], v14 offset:54528
s_waitcnt vmcnt(3) lgkmcnt(4)
v_mfma_f32_32x32x16_bf16 v[192:207], v[224:227], v[112:115], v[192:207]
v_mfma_f32_32x32x16_bf16 v[208:223], v[228:231], v[112:115], v[208:223]
ds_read_b64_tr_b16 v[224:225], v14 offset:26624
ds_read_b64_tr_b16 v[226:227], v14 offset:26880
ds_read_b64_tr_b16 v[228:229], v14 offset:55296
ds_read_b64_tr_b16 v[230:231], v14 offset:55552
s_waitcnt vmcnt(2) lgkmcnt(4)
v_mfma_f32_32x32x16_bf16 v[192:207], v[240:243], v[116:119], v[192:207]
v_mfma_f32_32x32x16_bf16 v[208:223], v[244:247], v[116:119], v[208:223]
ds_read_b64_tr_b16 v[240:241], v14 offset:27648
ds_read_b64_tr_b16 v[242:243], v14 offset:27904
ds_read_b64_tr_b16 v[244:245], v14 offset:56320
ds_read_b64_tr_b16 v[246:247], v14 offset:56576
s_waitcnt vmcnt(1) lgkmcnt(4)
v_mfma_f32_32x32x16_bf16 v[192:207], v[224:227], v[120:123], v[192:207]
v_mfma_f32_32x32x16_bf16 v[208:223], v[228:231], v[120:123], v[208:223]
s_waitcnt vmcnt(0) lgkmcnt(0)
v_mfma_f32_32x32x16_bf16 v[192:207], v[240:243], v[124:127], v[192:207]
v_mfma_f32_32x32x16_bf16 v[208:223], v[244:247], v[124:127], v[208:223]
s_nop 15
s_nop 3
s_cmp_ge_u32 s24, 7
s_cselect_b32 s40, 448, 0
s_cselect_b32 s41, 4194304, 0
s_cselect_b32 s42, 1.0, 1049335798
s_sub_u32 s40, s33, s40
s_lshl_b32 s43, s26, 21
s_add_u32 s41, s41, s43
s_lshr_b32 s43, s37, 5
s_lshl_b32 s43, s43, 11
s_add_u32 s41, s41, s43
s_add_u32 s44, s20, s41
s_addc_u32 s45, s21, 0
v_lshlrev_b32 v16, 4, v9
v_lshlrev_b32 v17, 2, v11
v_add_u32 v17, s40, v17
v_mov_b32 v26, 0
v_mov_b32 v27, 0
v_add_u32 v18, 0, v17
v_mul_u32_u24 v19, 2341, v18
v_lshrrev_b32 v19, 16, v19
v_mul_u32_u24 v20, 28, v19
v_sub_u32 v20, v18, v20
v_lshlrev_b32 v21, 17, v19
v_lshrrev_b32 v22, 3, v20
v_lshlrev_b32 v22, 9, v22
v_and_b32 v23, 7, v20
v_lshlrev_b32 v23, 1, v23
v_add3_u32 v21, v21, v22, v23
v_add_u32 v21, v21, v16
v_mul_f32 v192, s42, v192
v_mul_f32 v193, s42, v193
v_mul_f32 v194, s42, v194
v_mul_f32 v195, s42, v195
v_cvt_pk_bf16_f32 v24, v192, v193
v_cvt_pk_bf16_f32 v25, v194, v195
v_cmp_eq_u32 vcc, 24, v20
s_and_saveexec_b64 s[46:47], vcc
global_store_dwordx4 v21, v[24:27], s[44:45]
s_andn2_b64 exec, s[46:47], exec
global_store_dwordx2 v21, v[24:25], s[44:45]
s_mov_b64 exec, s[46:47]
s_nop 1
v_add_u32 v18, 8, v17
v_mul_u32_u24 v19, 2341, v18
v_lshrrev_b32 v19, 16, v19
v_mul_u32_u24 v20, 28, v19
v_sub_u32 v20, v18, v20
v_lshlrev_b32 v21, 17, v19
v_lshrrev_b32 v22, 3, v20
v_lshlrev_b32 v22, 9, v22
v_and_b32 v23, 7, v20
v_lshlrev_b32 v23, 1, v23
v_add3_u32 v21, v21, v22, v23
v_add_u32 v21, v21, v16
v_mul_f32 v196, s42, v196
v_mul_f32 v197, s42, v197
v_mul_f32 v198, s42, v198
v_mul_f32 v199, s42, v199
v_cvt_pk_bf16_f32 v24, v196, v197
v_cvt_pk_bf16_f32 v25, v198, v199
v_cmp_eq_u32 vcc, 24, v20
s_and_saveexec_b64 s[46:47], vcc
global_store_dwordx4 v21, v[24:27], s[44:45]
s_andn2_b64 exec, s[46:47], exec
global_store_dwordx2 v21, v[24:25], s[44:45]
s_mov_b64 exec, s[46:47]
s_nop 1
v_add_u32 v18, 16, v17
v_mul_u32_u24 v19, 2341, v18
v_lshrrev_b32 v19, 16, v19
v_mul_u32_u24 v20, 28, v19
v_sub_u32 v20, v18, v20
v_lshlrev_b32 v21, 17, v19
v_lshrrev_b32 v22, 3, v20
v_lshlrev_b32 v22, 9, v22
v_and_b32 v23, 7, v20
v_lshlrev_b32 v23, 1, v23
v_add3_u32 v21, v21, v22, v23
v_add_u32 v21, v21, v16
v_mul_f32 v200, s42, v200
v_mul_f32 v201, s42, v201
v_mul_f32 v202, s42, v202
v_mul_f32 v203, s42, v203
v_cvt_pk_bf16_f32 v24, v200, v201
v_cvt_pk_bf16_f32 v25, v202, v203
v_cmp_eq_u32 vcc, 24, v20
s_and_saveexec_b64 s[46:47], vcc
global_store_dwordx4 v21, v[24:27], s[44:45]
s_andn2_b64 exec, s[46:47], exec
global_store_dwordx2 v21, v[24:25], s[44:45]
s_mov_b64 exec, s[46:47]
s_nop 1
v_add_u32 v18, 24, v17
v_mul_u32_u24 v19, 2341, v18
v_lshrrev_b32 v19, 16, v19
v_mul_u32_u24 v20, 28, v19
v_sub_u32 v20, v18, v20
v_lshlrev_b32 v21, 17, v19
v_lshrrev_b32 v22, 3, v20
v_lshlrev_b32 v22, 9, v22
v_and_b32 v23, 7, v20
v_lshlrev_b32 v23, 1, v23
v_add3_u32 v21, v21, v22, v23
v_add_u32 v21, v21, v16
v_mul_f32 v204, s42, v204
v_mul_f32 v205, s42, v205
v_mul_f32 v206, s42, v206
v_mul_f32 v207, s42, v207
v_cvt_pk_bf16_f32 v24, v204, v205
v_cvt_pk_bf16_f32 v25, v206, v207
v_cmp_eq_u32 vcc, 24, v20
s_and_saveexec_b64 s[46:47], vcc
global_store_dwordx4 v21, v[24:27], s[44:45]
s_andn2_b64 exec, s[46:47], exec
global_store_dwordx2 v21, v[24:25], s[44:45]
s_mov_b64 exec, s[46:47]
s_nop 1
v_add_u32 v18, 32, v17
v_mul_u32_u24 v19, 2341, v18
v_lshrrev_b32 v19, 16, v19
v_mul_u32_u24 v20, 28, v19
v_sub_u32 v20, v18, v20
v_lshlrev_b32 v21, 17, v19
v_lshrrev_b32 v22, 3, v20
v_lshlrev_b32 v22, 9, v22
v_and_b32 v23, 7, v20
v_lshlrev_b32 v23, 1, v23
v_add3_u32 v21, v21, v22, v23
v_add_u32 v21, v21, v16
v_mul_f32 v208, s42, v208
v_mul_f32 v209, s42, v209
v_mul_f32 v210, s42, v210
v_mul_f32 v211, s42, v211
v_cvt_pk_bf16_f32 v24, v208, v209
v_cvt_pk_bf16_f32 v25, v210, v211
v_cmp_eq_u32 vcc, 24, v20
s_and_saveexec_b64 s[46:47], vcc
global_store_dwordx4 v21, v[24:27], s[44:45]
s_andn2_b64 exec, s[46:47], exec
global_store_dwordx2 v21, v[24:25], s[44:45]
s_mov_b64 exec, s[46:47]
s_nop 1
v_add_u32 v18, 40, v17
v_mul_u32_u24 v19, 2341, v18
v_lshrrev_b32 v19, 16, v19
v_mul_u32_u24 v20, 28, v19
v_sub_u32 v20, v18, v20
v_lshlrev_b32 v21, 17, v19
v_lshrrev_b32 v22, 3, v20
v_lshlrev_b32 v22, 9, v22
v_and_b32 v23, 7, v20
v_lshlrev_b32 v23, 1, v23
v_add3_u32 v21, v21, v22, v23
v_add_u32 v21, v21, v16
v_mul_f32 v212, s42, v212
v_mul_f32 v213, s42, v213
v_mul_f32 v214, s42, v214
v_mul_f32 v215, s42, v215
v_cvt_pk_bf16_f32 v24, v212, v213
v_cvt_pk_bf16_f32 v25, v214, v215
v_cmp_eq_u32 vcc, 24, v20
s_and_saveexec_b64 s[46:47], vcc
global_store_dwordx4 v21, v[24:27], s[44:45]
s_andn2_b64 exec, s[46:47], exec
global_store_dwordx2 v21, v[24:25], s[44:45]
s_mov_b64 exec, s[46:47]
s_nop 1
v_add_u32 v18, 48, v17
v_mul_u32_u24 v19, 2341, v18
v_lshrrev_b32 v19, 16, v19
v_mul_u32_u24 v20, 28, v19
v_sub_u32 v20, v18, v20
v_lshlrev_b32 v21, 17, v19
v_lshrrev_b32 v22, 3, v20
v_lshlrev_b32 v22, 9, v22
v_and_b32 v23, 7, v20
v_lshlrev_b32 v23, 1, v23
v_add3_u32 v21, v21, v22, v23
v_add_u32 v21, v21, v16
v_mul_f32 v216, s42, v216
v_mul_f32 v217, s42, v217
v_mul_f32 v218, s42, v218
v_mul_f32 v219, s42, v219
v_cvt_pk_bf16_f32 v24, v216, v217
v_cvt_pk_bf16_f32 v25, v218, v219
v_cmp_eq_u32 vcc, 24, v20
s_and_saveexec_b64 s[46:47], vcc
global_store_dwordx4 v21, v[24:27], s[44:45]
s_andn2_b64 exec, s[46:47], exec
global_store_dwordx2 v21, v[24:25], s[44:45]
s_mov_b64 exec, s[46:47]
s_nop 1
v_add_u32 v18, 56, v17
v_mul_u32_u24 v19, 2341, v18
v_lshrrev_b32 v19, 16, v19
v_mul_u32_u24 v20, 28, v19
v_sub_u32 v20, v18, v20
v_lshlrev_b32 v21, 17, v19
v_lshrrev_b32 v22, 3, v20
v_lshlrev_b32 v22, 9, v22
v_and_b32 v23, 7, v20
v_lshlrev_b32 v23, 1, v23
v_add3_u32 v21, v21, v22, v23
v_add_u32 v21, v21, v16
v_mul_f32 v220, s42, v220
v_mul_f32 v221, s42, v221
v_mul_f32 v222, s42, v222
v_mul_f32 v223, s42, v223
v_cvt_pk_bf16_f32 v24, v220, v221
v_cvt_pk_bf16_f32 v25, v222, v223
v_cmp_eq_u32 vcc, 24, v20
s_and_saveexec_b64 s[46:47], vcc
global_store_dwordx4 v21, v[24:27], s[44:45]
s_andn2_b64 exec, s[46:47], exec
global_store_dwordx2 v21, v[24:25], s[44:45]
s_mov_b64 exec, s[46:47]
s_nop 1
s_branch qkv_kernel_end
qkv_kernel_v:
ds_read_b64_tr_b16 v[224:225], v14 offset:0
ds_read_b64_tr_b16 v[226:227], v14 offset:256
ds_read_b64_tr_b16 v[228:229], v14 offset:28672
ds_read_b64_tr_b16 v[230:231], v14 offset:28928
ds_read_b64_tr_b16 v[240:241], v14 offset:1024
ds_read_b64_tr_b16 v[242:243], v14 offset:1280
ds_read_b64_tr_b16 v[244:245], v14 offset:29696
ds_read_b64_tr_b16 v[246:247], v14 offset:29952
s_waitcnt vmcnt(27) lgkmcnt(4)
v_mfma_f32_32x32x16_bf16 v[192:207], v[16:19], v[224:227], v[192:207]
v_mfma_f32_32x32x16_bf16 v[208:223], v[16:19], v[228:231], v[208:223]
ds_read_b64_tr_b16 v[224:225], v14 offset:2048
ds_read_b64_tr_b16 v[226:227], v14 offset:2304
ds_read_b64_tr_b16 v[228:229], v14 offset:30720
ds_read_b64_tr_b16 v[230:231], v14 offset:30976
s_waitcnt vmcnt(26) lgkmcnt(4)
v_mfma_f32_32x32x16_bf16 v[192:207], v[20:23], v[240:243], v[192:207]
v_mfma_f32_32x32x16_bf16 v[208:223], v[20:23], v[244:247], v[208:223]
ds_read_b64_tr_b16 v[240:241], v14 offset:3072
ds_read_b64_tr_b16 v[242:243], v14 offset:3328
ds_read_b64_tr_b16 v[244:245], v14 offset:31744
ds_read_b64_tr_b16 v[246:247], v14 offset:32000
s_waitcnt vmcnt(25) lgkmcnt(4)
v_mfma_f32_32x32x16_bf16 v[192:207], v[24:27], v[224:227], v[192:207]
v_mfma_f32_32x32x16_bf16 v[208:223], v[24:27], v[228:231], v[208:223]
ds_read_b64_tr_b16 v[224:225], v14 offset:4096
ds_read_b64_tr_b16 v[226:227], v14 offset:4352
ds_read_b64_tr_b16 v[228:229], v14 offset:32768
ds_read_b64_tr_b16 v[230:231], v14 offset:33024
s_waitcnt vmcnt(24) lgkmcnt(4)
v_mfma_f32_32x32x16_bf16 v[192:207], v[28:31], v[240:243], v[192:207]
v_mfma_f32_32x32x16_bf16 v[208:223], v[28:31], v[244:247], v[208:223]
ds_read_b64_tr_b16 v[240:241], v14 offset:5120
ds_read_b64_tr_b16 v[242:243], v14 offset:5376
ds_read_b64_tr_b16 v[244:245], v14 offset:33792
ds_read_b64_tr_b16 v[246:247], v14 offset:34048
s_waitcnt vmcnt(23) lgkmcnt(4)
v_mfma_f32_32x32x16_bf16 v[192:207], v[32:35], v[224:227], v[192:207]
v_mfma_f32_32x32x16_bf16 v[208:223], v[32:35], v[228:231], v[208:223]
ds_read_b64_tr_b16 v[224:225], v14 offset:6144
ds_read_b64_tr_b16 v[226:227], v14 offset:6400
ds_read_b64_tr_b16 v[228:229], v14 offset:34816
ds_read_b64_tr_b16 v[230:231], v14 offset:35072
s_waitcnt vmcnt(22) lgkmcnt(4)
v_mfma_f32_32x32x16_bf16 v[192:207], v[36:39], v[240:243], v[192:207]
v_mfma_f32_32x32x16_bf16 v[208:223], v[36:39], v[244:247], v[208:223]
ds_read_b64_tr_b16 v[240:241], v14 offset:7168
ds_read_b64_tr_b16 v[242:243], v14 offset:7424
ds_read_b64_tr_b16 v[244:245], v14 offset:35840
ds_read_b64_tr_b16 v[246:247], v14 offset:36096
s_waitcnt vmcnt(21) lgkmcnt(4)
v_mfma_f32_32x32x16_bf16 v[192:207], v[40:43], v[224:227], v[192:207]
v_mfma_f32_32x32x16_bf16 v[208:223], v[40:43], v[228:231], v[208:223]
ds_read_b64_tr_b16 v[224:225], v14 offset:8192
ds_read_b64_tr_b16 v[226:227], v14 offset:8448
ds_read_b64_tr_b16 v[228:229], v14 offset:36864
ds_read_b64_tr_b16 v[230:231], v14 offset:37120
s_waitcnt vmcnt(20) lgkmcnt(4)
v_mfma_f32_32x32x16_bf16 v[192:207], v[44:47], v[240:243], v[192:207]
v_mfma_f32_32x32x16_bf16 v[208:223], v[44:47], v[244:247], v[208:223]
ds_read_b64_tr_b16 v[240:241], v14 offset:9216
ds_read_b64_tr_b16 v[242:243], v14 offset:9472
ds_read_b64_tr_b16 v[244:245], v14 offset:37888
ds_read_b64_tr_b16 v[246:247], v14 offset:38144
s_waitcnt vmcnt(19) lgkmcnt(4)
v_mfma_f32_32x32x16_bf16 v[192:207], v[48:51], v[224:227], v[192:207]
v_mfma_f32_32x32x16_bf16 v[208:223], v[48:51], v[228:231], v[208:223]
ds_read_b64_tr_b16 v[224:225], v14 offset:10240
ds_read_b64_tr_b16 v[226:227], v14 offset:10496
ds_read_b64_tr_b16 v[228:229], v14 offset:38912
ds_read_b64_tr_b16 v[230:231], v14 offset:39168
s_waitcnt vmcnt(18) lgkmcnt(4)
v_mfma_f32_32x32x16_bf16 v[192:207], v[52:55], v[240:243], v[192:207]
v_mfma_f32_32x32x16_bf16 v[208:223], v[52:55], v[244:247], v[208:223]
ds_read_b64_tr_b16 v[240:241], v14 offset:11264
ds_read_b64_tr_b16 v[242:243], v14 offset:11520
ds_read_b64_tr_b16 v[244:245], v14 offset:39936
ds_read_b64_tr_b16 v[246:247], v14 offset:40192
s_waitcnt vmcnt(17) lgkmcnt(4)
v_mfma_f32_32x32x16_bf16 v[192:207], v[56:59], v[224:227], v[192:207]
v_mfma_f32_32x32x16_bf16 v[208:223], v[56:59], v[228:231], v[208:223]
ds_read_b64_tr_b16 v[224:225], v14 offset:12288
ds_read_b64_tr_b16 v[226:227], v14 offset:12544
ds_read_b64_tr_b16 v[228:229], v14 offset:40960
ds_read_b64_tr_b16 v[230:231], v14 offset:41216
s_waitcnt vmcnt(16) lgkmcnt(4)
v_mfma_f32_32x32x16_bf16 v[192:207], v[60:63], v[240:243], v[192:207]
v_mfma_f32_32x32x16_bf16 v[208:223], v[60:63], v[244:247], v[208:223]
ds_read_b64_tr_b16 v[240:241], v14 offset:13312
ds_read_b64_tr_b16 v[242:243], v14 offset:13568
ds_read_b64_tr_b16 v[244:245], v14 offset:41984
ds_read_b64_tr_b16 v[246:247], v14 offset:42240
s_waitcnt vmcnt(15) lgkmcnt(4)
v_mfma_f32_32x32x16_bf16 v[192:207], v[64:67], v[224:227], v[192:207]
v_mfma_f32_32x32x16_bf16 v[208:223], v[64:67], v[228:231], v[208:223]
ds_read_b64_tr_b16 v[224:225], v14 offset:14336
ds_read_b64_tr_b16 v[226:227], v14 offset:14592
ds_read_b64_tr_b16 v[228:229], v14 offset:43008
ds_read_b64_tr_b16 v[230:231], v14 offset:43264
s_waitcnt vmcnt(14) lgkmcnt(4)
v_mfma_f32_32x32x16_bf16 v[192:207], v[68:71], v[240:243], v[192:207]
v_mfma_f32_32x32x16_bf16 v[208:223], v[68:71], v[244:247], v[208:223]
ds_read_b64_tr_b16 v[240:241], v14 offset:15360
ds_read_b64_tr_b16 v[242:243], v14 offset:15616
ds_read_b64_tr_b16 v[244:245], v14 offset:44032
ds_read_b64_tr_b16 v[246:247], v14 offset:44288
s_waitcnt vmcnt(13) lgkmcnt(4)
v_mfma_f32_32x32x16_bf16 v[192:207], v[72:75], v[224:227], v[192:207]
v_mfma_f32_32x32x16_bf16 v[208:223], v[72:75], v[228:231], v[208:223]
ds_read_b64_tr_b16 v[224:225], v14 offset:16384
ds_read_b64_tr_b16 v[226:227], v14 offset:16640
ds_read_b64_tr_b16 v[228:229], v14 offset:45056
ds_read_b64_tr_b16 v[230:231], v14 offset:45312
s_waitcnt vmcnt(12) lgkmcnt(4)
v_mfma_f32_32x32x16_bf16 v[192:207], v[76:79], v[240:243], v[192:207]
v_mfma_f32_32x32x16_bf16 v[208:223], v[76:79], v[244:247], v[208:223]
ds_read_b64_tr_b16 v[240:241], v14 offset:17408
ds_read_b64_tr_b16 v[242:243], v14 offset:17664
ds_read_b64_tr_b16 v[244:245], v14 offset:46080
ds_read_b64_tr_b16 v[246:247], v14 offset:46336
s_waitcnt vmcnt(11) lgkmcnt(4)
v_mfma_f32_32x32x16_bf16 v[192:207], v[80:83], v[224:227], v[192:207]
v_mfma_f32_32x32x16_bf16 v[208:223], v[80:83], v[228:231], v[208:223]
ds_read_b64_tr_b16 v[224:225], v14 offset:18432
ds_read_b64_tr_b16 v[226:227], v14 offset:18688
ds_read_b64_tr_b16 v[228:229], v14 offset:47104
ds_read_b64_tr_b16 v[230:231], v14 offset:47360
s_waitcnt vmcnt(10) lgkmcnt(4)
v_mfma_f32_32x32x16_bf16 v[192:207], v[84:87], v[240:243], v[192:207]
v_mfma_f32_32x32x16_bf16 v[208:223], v[84:87], v[244:247], v[208:223]
ds_read_b64_tr_b16 v[240:241], v14 offset:19456
ds_read_b64_tr_b16 v[242:243], v14 offset:19712
ds_read_b64_tr_b16 v[244:245], v14 offset:48128
ds_read_b64_tr_b16 v[246:247], v14 offset:48384
s_waitcnt vmcnt(9) lgkmcnt(4)
v_mfma_f32_32x32x16_bf16 v[192:207], v[88:91], v[224:227], v[192:207]
v_mfma_f32_32x32x16_bf16 v[208:223], v[88:91], v[228:231], v[208:223]
ds_read_b64_tr_b16 v[224:225], v14 offset:20480
ds_read_b64_tr_b16 v[226:227], v14 offset:20736
ds_read_b64_tr_b16 v[228:229], v14 offset:49152
ds_read_b64_tr_b16 v[230:231], v14 offset:49408
s_waitcnt vmcnt(8) lgkmcnt(4)
v_mfma_f32_32x32x16_bf16 v[192:207], v[92:95], v[240:243], v[192:207]
v_mfma_f32_32x32x16_bf16 v[208:223], v[92:95], v[244:247], v[208:223]
ds_read_b64_tr_b16 v[240:241], v14 offset:21504
ds_read_b64_tr_b16 v[242:243], v14 offset:21760
ds_read_b64_tr_b16 v[244:245], v14 offset:50176
ds_read_b64_tr_b16 v[246:247], v14 offset:50432
s_waitcnt vmcnt(7) lgkmcnt(4)
v_mfma_f32_32x32x16_bf16 v[192:207], v[96:99], v[224:227], v[192:207]
v_mfma_f32_32x32x16_bf16 v[208:223], v[96:99], v[228:231], v[208:223]
ds_read_b64_tr_b16 v[224:225], v14 offset:22528
ds_read_b64_tr_b16 v[226:227], v14 offset:22784
ds_read_b64_tr_b16 v[228:229], v14 offset:51200
ds_read_b64_tr_b16 v[230:231], v14 offset:51456
s_waitcnt vmcnt(6) lgkmcnt(4)
v_mfma_f32_32x32x16_bf16 v[192:207], v[100:103], v[240:243], v[192:207]
v_mfma_f32_32x32x16_bf16 v[208:223], v[100:103], v[244:247], v[208:223]
ds_read_b64_tr_b16 v[240:241], v14 offset:23552
ds_read_b64_tr_b16 v[242:243], v14 offset:23808
ds_read_b64_tr_b16 v[244:245], v14 offset:52224
ds_read_b64_tr_b16 v[246:247], v14 offset:52480
s_waitcnt vmcnt(5) lgkmcnt(4)
v_mfma_f32_32x32x16_bf16 v[192:207], v[104:107], v[224:227], v[192:207]
v_mfma_f32_32x32x16_bf16 v[208:223], v[104:107], v[228:231], v[208:223]
ds_read_b64_tr_b16 v[224:225], v14 offset:24576
ds_read_b64_tr_b16 v[226:227], v14 offset:24832
ds_read_b64_tr_b16 v[228:229], v14 offset:53248
ds_read_b64_tr_b16 v[230:231], v14 offset:53504
s_waitcnt vmcnt(4) lgkmcnt(4)
v_mfma_f32_32x32x16_bf16 v[192:207], v[108:111], v[240:243], v[192:207]
v_mfma_f32_32x32x16_bf16 v[208:223], v[108:111], v[244:247], v[208:223]
ds_read_b64_tr_b16 v[240:241], v14 offset:25600
ds_read_b64_tr_b16 v[242:243], v14 offset:25856
ds_read_b64_tr_b16 v[244:245], v14 offset:54272
ds_read_b64_tr_b16 v[246:247], v14 offset:54528
s_waitcnt vmcnt(3) lgkmcnt(4)
v_mfma_f32_32x32x16_bf16 v[192:207], v[112:115], v[224:227], v[192:207]
v_mfma_f32_32x32x16_bf16 v[208:223], v[112:115], v[228:231], v[208:223]
ds_read_b64_tr_b16 v[224:225], v14 offset:26624
ds_read_b64_tr_b16 v[226:227], v14 offset:26880
ds_read_b64_tr_b16 v[228:229], v14 offset:55296
ds_read_b64_tr_b16 v[230:231], v14 offset:55552
s_waitcnt vmcnt(2) lgkmcnt(4)
v_mfma_f32_32x32x16_bf16 v[192:207], v[116:119], v[240:243], v[192:207]
v_mfma_f32_32x32x16_bf16 v[208:223], v[116:119], v[244:247], v[208:223]
ds_read_b64_tr_b16 v[240:241], v14 offset:27648
ds_read_b64_tr_b16 v[242:243], v14 offset:27904
ds_read_b64_tr_b16 v[244:245], v14 offset:56320
ds_read_b64_tr_b16 v[246:247], v14 offset:56576
s_waitcnt vmcnt(1) lgkmcnt(4)
v_mfma_f32_32x32x16_bf16 v[192:207], v[120:123], v[224:227], v[192:207]
v_mfma_f32_32x32x16_bf16 v[208:223], v[120:123], v[228:231], v[208:223]
s_waitcnt vmcnt(0) lgkmcnt(0)
v_mfma_f32_32x32x16_bf16 v[192:207], v[124:127], v[240:243], v[192:207]
v_mfma_f32_32x32x16_bf16 v[208:223], v[124:127], v[244:247], v[208:223]
s_nop 15
s_nop 3
s_lshl_b32 s43, s26, 21
s_add_u32 s41, s43, 8388608
s_lshr_b32 s43, s37, 5
s_lshl_b32 s43, s43, 11
s_add_u32 s41, s41, s43
s_add_u32 s44, s20, s41
s_addc_u32 s45, s21, 0
s_sub_u32 s40, s33, 896
v_add_u32 v18, s40, v9
v_add_u32 v18, 0, v18
v_mul_u32_u24 v19, 2341, v18
v_lshrrev_b32 v19, 16, v19
v_mul_u32_u24 v20, 28, v19
v_sub_u32 v20, v18, v20
v_lshlrev_b32 v21, 17, v19
v_lshlrev_b32 v22, 4, v20
v_lshlrev_b32 v23, 9, v11
v_add3_u32 v21, v21, v22, v23
v_cvt_pk_bf16_f32 v24, v192, v193
v_cvt_pk_bf16_f32 v25, v194, v195
v_cvt_pk_bf16_f32 v26, v196, v197
v_cvt_pk_bf16_f32 v27, v198, v199
global_store_dwordx4 v21, v[24:27], s[44:45] offset:0
s_nop 1
v_cvt_pk_bf16_f32 v24, v200, v201
v_cvt_pk_bf16_f32 v25, v202, v203
v_cvt_pk_bf16_f32 v26, v204, v205
v_cvt_pk_bf16_f32 v27, v206, v207
global_store_dwordx4 v21, v[24:27], s[44:45] offset:1024
s_nop 1
v_add_u32 v18, s40, v9
v_add_u32 v18, 32, v18
v_mul_u32_u24 v19, 2341, v18
v_lshrrev_b32 v19, 16, v19
v_mul_u32_u24 v20, 28, v19
v_sub_u32 v20, v18, v20
v_lshlrev_b32 v21, 17, v19
v_lshlrev_b32 v22, 4, v20
v_lshlrev_b32 v23, 9, v11
v_add3_u32 v21, v21, v22, v23
v_cvt_pk_bf16_f32 v24, v208, v209
v_cvt_pk_bf16_f32 v25, v210, v211
v_cvt_pk_bf16_f32 v26, v212, v213
v_cvt_pk_bf16_f32 v27, v214, v215
global_store_dwordx4 v21, v[24:27], s[44:45] offset:0
s_nop 1
v_cvt_pk_bf16_f32 v24, v216, v217
v_cvt_pk_bf16_f32 v25, v218, v219
v_cvt_pk_bf16_f32 v26, v220, v221
v_cvt_pk_bf16_f32 v27, v222, v223
global_store_dwordx4 v21, v[24:27], s[44:45] offset:1024
s_nop 1
s_sub_u32 s48, s24, 14
s_mul_i32 s49, s27, 7
s_add_u32 s48, s48, s49
s_cmp_ge_u32 s48, 16
s_cbranch_scc1 qkv_kernel_end
s_lshl_b32 s43, s26, 21
s_add_u32 s41, s43, 8388608
s_lshl_b32 s43, s48, 17
s_add_u32 s41, s41, s43
s_lshl_b32 s43, s25, 13
s_add_u32 s41, s41, s43
s_add_u32 s44, s20, s41
s_addc_u32 s45, s21, 0
v_lshrrev_b32 v18, 3, v2
v_lshlrev_b32 v18, 10, v18
v_lshrrev_b32 v19, 2, v2
v_and_b32 v19, 1, v19
v_lshlrev_b32 v19, 9, v19
v_and_b32 v20, 3, v2
v_add_u32 v21, 28, v20
v_lshlrev_b32 v21, 4, v21
v_add3_u32 v18, v18, v19, v21
v_cmp_eq_u32 vcc, 0, v20
v_mov_b32 v22, 0x3f803f80
s_nop 1
v_cndmask_b32 v24, 0, v22, vcc
v_mov_b32 v25, v24
v_mov_b32 v26, v24
v_mov_b32 v27, v24
global_store_dwordx4 v18, v[24:27], s[44:45]
qkv_kernel_end:
s_endpgm
.globl attn_kernel
.p2align 8
.type attn_kernel,@function
attn_kernel:
s_cmp_ge_u32 s2, 512
s_cbranch_scc1 attn_kernel_end
s_load_dwordx2 s[20:21], s[0:1], 64
s_and_b32 s3, s2, 7
s_lshr_b32 s4, s2, 3
s_and_b32 s5, s4, 3
s_lshl_b32 s3, s3, 2
s_add_u32 s3, s3, s5
s_lshr_b32 s4, s4, 2
v_lshrrev_b32 v1, 6, v0
v_and_b32 v2, 63, v0
s_nop 0
v_readfirstlane_b32 s5, v1
s_lshl_b32 s6, s4, 2
s_add_u32 s6, s6, s5
s_lshl_b32 s7, s3, 17
s_waitcnt lgkmcnt(0)
s_lshl_b32 s8, s6, 11
s_add_u32 s8, s8, s7
s_add_u32 s10, s20, s8
s_addc_u32 s11, s21, 0
s_add_u32 s8, s7, 4194304
s_add_u32 s12, s20, s8
s_addc_u32 s13, s21, 0
s_add_u32 s8, s7, 8388608
s_add_u32 s14, s20, s8
s_addc_u32 s15, s21, 0
v_lshlrev_b32 v3, 4, v2
global_load_dwordx4 v[8:11], v3, s[10:11]
global_load_dwordx4 v[12:15], v3, s[10:11] offset:1024
s_lshl_b32 s16, s5, 11
v_add_u32 v4, s16, v3
s_mov_b32 s18, 0
s_mov_b32 s19, 16384
s_add_u32 s17, s18, s16
s_mov_b32 m0, s17
s_nop 0
global_load_lds_dwordx4 v4, s[12:13]
global_load_lds_dwordx4 v4, s[12:13] offset:1024
s_add_u32 s17, s17, 8192
s_mov_b32 m0, s17
s_nop 0
global_load_lds_dwordx4 v4, s[14:15]
global_load_lds_dwordx4 v4, s[14:15] offset:1024
v_add_u32 v4, 8192, v4
s_add_u32 s17, s19, s16
s_mov_b32 m0, s17
s_nop 0
global_load_lds_dwordx4 v4, s[12:13]
global_load_lds_dwordx4 v4, s[12:13] offset:1024
s_add_u32 s17, s17, 8192
s_mov_b32 m0, s17
s_nop 0
global_load_lds_dwordx4 v4, s[14:15]
global_load_lds_dwordx4 v4, s[14:15] offset:1024
v_add_u32 v4, 8192, v4
v_mov_b32 v64, 0
v_mov_b32 v80, 0
v_mov_b32 v65, 0
v_mov_b32 v81, 0
v_mov_b32 v66, 0
v_mov_b32 v82, 0
v_mov_b32 v67, 0
v_mov_b32 v83, 0
v_mov_b32 v68, 0
v_mov_b32 v84, 0
v_mov_b32 v69, 0
v_mov_b32 v85, 0
v_mov_b32 v70, 0
v_mov_b32 v86, 0
v_mov_b32 v71, 0
v_mov_b32 v87, 0
v_mov_b32 v72, 0
v_mov_b32 v88, 0
v_mov_b32 v73, 0
v_mov_b32 v89, 0
v_mov_b32 v74, 0
v_mov_b32 v90, 0
v_mov_b32 v75, 0
v_mov_b32 v91, 0
v_mov_b32 v76, 0
v_mov_b32 v92, 0
v_mov_b32 v77, 0
v_mov_b32 v93, 0
v_mov_b32 v78, 0
v_mov_b32 v94, 0
v_mov_b32 v79, 0
v_mov_b32 v95, 0
v_mov_b32 v5, 0xff800000
v_mov_b32 v6, 0xff800000
s_waitcnt vmcnt(4)
s_barrier
ds_read_b128 v[96:99], v3 offset:0
ds_read_b128 v[100:103], v3 offset:1024
ds_read_b128 v[112:115], v3 offset:8192
ds_read_b128 v[116:119], v3 offset:9216
s_waitcnt lgkmcnt(0)
v_mfma_f32_32x32x16_bf16 v[32:47], v[96:99], v[8:11], v[80:95]
v_mfma_f32_32x32x16_bf16 v[32:47], v[100:103], v[12:15], v[32:47]
s_nop 15
s_mov_b32 s22, 0
attn_loop:
ds_read_b128 v[104:107], v3 offset:2048
ds_read_b128 v[108:111], v3 offset:3072
ds_read_b128 v[120:123], v3 offset:10240
ds_read_b128 v[124:127], v3 offset:11264
v_max3_f32 v7, v32, v33, v34
v_max3_f32 v7, v7, v35, v36
v_max3_f32 v7, v7, v37, v38
v_max3_f32 v7, v7, v39, v40
v_max3_f32 v7, v7, v41, v42
v_max3_f32 v7, v7, v43, v44
v_max3_f32 v7, v7, v45, v46
v_max_f32 v7, v7, v47
v_cmp_gt_f32 vcc, v7, v5
s_cbranch_vccnz aL_rare0
aL_back0:
v_exp_f32 v32, v32
v_exp_f32 v33, v33
v_exp_f32 v34, v34
v_exp_f32 v35, v35
v_exp_f32 v36, v36
v_exp_f32 v37, v37
v_exp_f32 v38, v38
v_exp_f32 v39, v39
s_waitcnt lgkmcnt(2)
v_mfma_f32_32x32x16_bf16 v[48:63], v[104:107], v[8:11], v[80:95]
v_mfma_f32_32x32x16_bf16 v[48:63], v[108:111], v[12:15], v[48:63]
v_exp_f32 v40, v40
v_exp_f32 v41, v41
v_exp_f32 v42, v42
v_exp_f32 v43, v43
v_exp_f32 v44, v44
v_exp_f32 v45, v45
v_exp_f32 v46, v46
v_exp_f32 v47, v47
v_cvt_pk_bf16_f32 v16, v32, v33
v_cvt_pk_bf16_f32 v17, v34, v35
v_cvt_pk_bf16_f32 v18, v36, v37
v_cvt_pk_bf16_f32 v19, v38, v39
v_cvt_pk_bf16_f32 v20, v40, v41
v_cvt_pk_bf16_f32 v21, v42, v43
v_cvt_pk_bf16_f32 v22, v44, v45
v_cvt_pk_bf16_f32 v23, v46, v47
s_nop 1
v_mfma_f32_32x32x16_bf16 v[64:79], v[112:115], v[16:19], v[64:79]
v_mfma_f32_32x32x16_bf16 v[64:79], v[116:119], v[20:23], v[64:79]
ds_read_b128 v[96:99], v3 offset:4096
ds_read_b128 v[100:103], v3 offset:5120
ds_read_b128 v[112:115], v3 offset:12288
ds_read_b128 v[116:119], v3 offset:13312
v_max3_f32 v7, v48, v49, v50
v_max3_f32 v7, v7, v51, v52
v_max3_f32 v7, v7, v53, v54
v_max3_f32 v7, v7, v55, v56
v_max3_f32 v7, v7, v57, v58
v_max3_f32 v7, v7, v59, v60
v_max3_f32 v7, v7, v61, v62
v_max_f32 v7, v7, v63
v_cmp_gt_f32 vcc, v7, v5
s_cbranch_vccnz aL_rare1
aL_back1:
v_exp_f32 v48, v48
v_exp_f32 v49, v49
v_exp_f32 v50, v50
v_exp_f32 v51, v51
v_exp_f32 v52, v52
v_exp_f32 v53, v53
v_exp_f32 v54, v54
v_exp_f32 v55, v55
s_waitcnt lgkmcnt(2)
v_mfma_f32_32x32x16_bf16 v[32:47], v[96:99], v[8:11], v[80:95]
v_mfma_f32_32x32x16_bf16 v[32:47], v[100:103], v[12:15], v[32:47]
v_exp_f32 v56, v56
v_exp_f32 v57, v57
v_exp_f32 v58, v58
v_exp_f32 v59, v59
v_exp_f32 v60, v60
v_exp_f32 v61, v61
v_exp_f32 v62, v62
v_exp_f32 v63, v63
v_cvt_pk_bf16_f32 v16, v48, v49
v_cvt_pk_bf16_f32 v17, v50, v51
v_cvt_pk_bf16_f32 v18, v52, v53
v_cvt_pk_bf16_f32 v19, v54, v55
v_cvt_pk_bf16_f32 v20, v56, v57
v_cvt_pk_bf16_f32 v21, v58, v59
v_cvt_pk_bf16_f32 v22, v60, v61
v_cvt_pk_bf16_f32 v23, v62, v63
s_nop 1
v_mfma_f32_32x32x16_bf16 v[64:79], v[120:123], v[16:19], v[64:79]
v_mfma_f32_32x32x16_bf16 v[64:79], v[124:127], v[20:23], v[64:79]
ds_read_b128 v[104:107], v3 offset:6144
ds_read_b128 v[108:111], v3 offset:7168
ds_read_b128 v[120:123], v3 offset:14336
ds_read_b128 v[124:127], v3 offset:15360
v_max3_f32 v7, v32, v33, v34
v_max3_f32 v7, v7, v35, v36
v_max3_f32 v7, v7, v37, v38
v_max3_f32 v7, v7, v39, v40
v_max3_f32 v7, v7, v41, v42
v_max3_f32 v7, v7, v43, v44
v_max3_f32 v7, v7, v45, v46
v_max_f32 v7, v7, v47
v_cmp_gt_f32 vcc, v7, v5
s_cbranch_vccnz aL_rare2
aL_back2:
v_exp_f32 v32, v32
v_exp_f32 v33, v33
v_exp_f32 v34, v34
v_exp_f32 v35, v35
v_exp_f32 v36, v36
v_exp_f32 v37, v37
v_exp_f32 v38, v38
v_exp_f32 v39, v39
s_waitcnt lgkmcnt(2)
v_mfma_f32_32x32x16_bf16 v[48:63], v[104:107], v[8:11], v[80:95]
v_mfma_f32_32x32x16_bf16 v[48:63], v[108:111], v[12:15], v[48:63]
v_exp_f32 v40, v40
v_exp_f32 v41, v41
v_exp_f32 v42, v42
v_exp_f32 v43, v43
v_exp_f32 v44, v44
v_exp_f32 v45, v45
v_exp_f32 v46, v46
v_exp_f32 v47, v47
v_cvt_pk_bf16_f32 v16, v32, v33
v_cvt_pk_bf16_f32 v17, v34, v35
v_cvt_pk_bf16_f32 v18, v36, v37
v_cvt_pk_bf16_f32 v19, v38, v39
v_cvt_pk_bf16_f32 v20, v40, v41
v_cvt_pk_bf16_f32 v21, v42, v43
v_cvt_pk_bf16_f32 v22, v44, v45
v_cvt_pk_bf16_f32 v23, v46, v47
s_nop 1
v_mfma_f32_32x32x16_bf16 v[64:79], v[112:115], v[16:19], v[64:79]
v_mfma_f32_32x32x16_bf16 v[64:79], v[116:119], v[20:23], v[64:79]
s_waitcnt vmcnt(0) lgkmcnt(0)
s_barrier
s_cmp_ge_u32 s22, 14
s_cbranch_scc1 aL_nodma
s_add_u32 s17, s18, s16
s_mov_b32 m0, s17
s_nop 0
global_load_lds_dwordx4 v4, s[12:13]
global_load_lds_dwordx4 v4, s[12:13] offset:1024
s_add_u32 s17, s17, 8192
s_mov_b32 m0, s17
s_nop 0
global_load_lds_dwordx4 v4, s[14:15]
global_load_lds_dwordx4 v4, s[14:15] offset:1024
v_add_u32 v4, 8192, v4
aL_nodma:
s_xor_b32 s18, s18, 16384
v_xor_b32 v3, 16384, v3
ds_read_b128 v[96:99], v3 offset:0
ds_read_b128 v[100:103], v3 offset:1024
ds_read_b128 v[112:115], v3 offset:8192
ds_read_b128 v[116:119], v3 offset:9216
v_max3_f32 v7, v48, v49, v50
v_max3_f32 v7, v7, v51, v52
v_max3_f32 v7, v7, v53, v54
v_max3_f32 v7, v7, v55, v56
v_max3_f32 v7, v7, v57, v58
v_max3_f32 v7, v7, v59, v60
v_max3_f32 v7, v7, v61, v62
v_max_f32 v7, v7, v63
v_cmp_gt_f32 vcc, v7, v5
s_cbranch_vccnz aL_rare3
aL_back3:
v_exp_f32 v48, v48
v_exp_f32 v49, v49
v_exp_f32 v50, v50
v_exp_f32 v51, v51
v_exp_f32 v52, v52
v_exp_f32 v53, v53
v_exp_f32 v54, v54
v_exp_f32 v55, v55
s_waitcnt lgkmcnt(2)
v_mfma_f32_32x32x16_bf16 v[32:47], v[96:99], v[8:11], v[80:95]
v_mfma_f32_32x32x16_bf16 v[32:47], v[100:103], v[12:15], v[32:47]
v_exp_f32 v56, v56
v_exp_f32 v57, v57
v_exp_f32 v58, v58
v_exp_f32 v59, v59
v_exp_f32 v60, v60
v_exp_f32 v61, v61
v_exp_f32 v62, v62
v_exp_f32 v63, v63
v_cvt_pk_bf16_f32 v16, v48, v49
v_cvt_pk_bf16_f32 v17, v50, v51
v_cvt_pk_bf16_f32 v18, v52, v53
v_cvt_pk_bf16_f32 v19, v54, v55
v_cvt_pk_bf16_f32 v20, v56, v57
v_cvt_pk_bf16_f32 v21, v58, v59
v_cvt_pk_bf16_f32 v22, v60, v61
v_cvt_pk_bf16_f32 v23, v62, v63
s_nop 1
v_mfma_f32_32x32x16_bf16 v[64:79], v[120:123], v[16:19], v[64:79]
v_mfma_f32_32x32x16_bf16 v[64:79], v[124:127], v[20:23], v[64:79]
s_add_u32 s22, s22, 1
s_cmp_lt_u32 s22, 15
s_cbranch_scc1 attn_loop
ds_read_b128 v[104:107], v3 offset:2048
ds_read_b128 v[108:111], v3 offset:3072
ds_read_b128 v[120:123], v3 offset:10240
ds_read_b128 v[124:127], v3 offset:11264
v_max3_f32 v7, v32, v33, v34
v_max3_f32 v7, v7, v35, v36
v_max3_f32 v7, v7, v37, v38
v_max3_f32 v7, v7, v39, v40
v_max3_f32 v7, v7, v41, v42
v_max3_f32 v7, v7, v43, v44
v_max3_f32 v7, v7, v45, v46
v_max_f32 v7, v7, v47
v_cmp_gt_f32 vcc, v7, v5
s_cbranch_vccnz aF_rare0
aF_back0:
v_exp_f32 v32, v32
v_exp_f32 v33, v33
v_exp_f32 v34, v34
v_exp_f32 v35, v35
v_exp_f32 v36, v36
v_exp_f32 v37, v37
v_exp_f32 v38, v38
v_exp_f32 v39, v39
s_waitcnt lgkmcnt(2)
v_mfma_f32_32x32x16_bf16 v[48:63], v[104:107], v[8:11], v[80:95]
v_mfma_f32_32x32x16_bf16 v[48:63], v[108:111], v[12:15], v[48:63]
v_exp_f32 v40, v40
v_exp_f32 v41, v41
v_exp_f32 v42, v42
v_exp_f32 v43, v43
v_exp_f32 v44, v44
v_exp_f32 v45, v45
v_exp_f32 v46, v46
v_exp_f32 v47, v47
v_cvt_pk_bf16_f32 v16, v32, v33
v_cvt_pk_bf16_f32 v17, v34, v35
v_cvt_pk_bf16_f32 v18, v36, v37
v_cvt_pk_bf16_f32 v19, v38, v39
v_cvt_pk_bf16_f32 v20, v40, v41
v_cvt_pk_bf16_f32 v21, v42, v43
v_cvt_pk_bf16_f32 v22, v44, v45
v_cvt_pk_bf16_f32 v23, v46, v47
s_nop 1
v_mfma_f32_32x32x16_bf16 v[64:79], v[112:115], v[16:19], v[64:79]
v_mfma_f32_32x32x16_bf16 v[64:79], v[116:119], v[20:23], v[64:79]
ds_read_b128 v[96:99], v3 offset:4096
ds_read_b128 v[100:103], v3 offset:5120
ds_read_b128 v[112:115], v3 offset:12288
ds_read_b128 v[116:119], v3 offset:13312
v_max3_f32 v7, v48, v49, v50
v_max3_f32 v7, v7, v51, v52
v_max3_f32 v7, v7, v53, v54
v_max3_f32 v7, v7, v55, v56
v_max3_f32 v7, v7, v57, v58
v_max3_f32 v7, v7, v59, v60
v_max3_f32 v7, v7, v61, v62
v_max_f32 v7, v7, v63
v_cmp_gt_f32 vcc, v7, v5
s_cbranch_vccnz aF_rare1
aF_back1:
v_exp_f32 v48, v48
v_exp_f32 v49, v49
v_exp_f32 v50, v50
v_exp_f32 v51, v51
v_exp_f32 v52, v52
v_exp_f32 v53, v53
v_exp_f32 v54, v54
v_exp_f32 v55, v55
s_waitcnt lgkmcnt(2)
v_mfma_f32_32x32x16_bf16 v[32:47], v[96:99], v[8:11], v[80:95]
v_mfma_f32_32x32x16_bf16 v[32:47], v[100:103], v[12:15], v[32:47]
v_exp_f32 v56, v56
v_exp_f32 v57, v57
v_exp_f32 v58, v58
v_exp_f32 v59, v59
v_exp_f32 v60, v60
v_exp_f32 v61, v61
v_exp_f32 v62, v62
v_exp_f32 v63, v63
v_cvt_pk_bf16_f32 v16, v48, v49
v_cvt_pk_bf16_f32 v17, v50, v51
v_cvt_pk_bf16_f32 v18, v52, v53
v_cvt_pk_bf16_f32 v19, v54, v55
v_cvt_pk_bf16_f32 v20, v56, v57
v_cvt_pk_bf16_f32 v21, v58, v59
v_cvt_pk_bf16_f32 v22, v60, v61
v_cvt_pk_bf16_f32 v23, v62, v63
s_nop 1
v_mfma_f32_32x32x16_bf16 v[64:79], v[120:123], v[16:19], v[64:79]
v_mfma_f32_32x32x16_bf16 v[64:79], v[124:127], v[20:23], v[64:79]
ds_read_b128 v[104:107], v3 offset:6144
ds_read_b128 v[108:111], v3 offset:7168
ds_read_b128 v[120:123], v3 offset:14336
ds_read_b128 v[124:127], v3 offset:15360
v_max3_f32 v7, v32, v33, v34
v_max3_f32 v7, v7, v35, v36
v_max3_f32 v7, v7, v37, v38
v_max3_f32 v7, v7, v39, v40
v_max3_f32 v7, v7, v41, v42
v_max3_f32 v7, v7, v43, v44
v_max3_f32 v7, v7, v45, v46
v_max_f32 v7, v7, v47
v_cmp_gt_f32 vcc, v7, v5
s_cbranch_vccnz aF_rare2
aF_back2:
v_exp_f32 v32, v32
v_exp_f32 v33, v33
v_exp_f32 v34, v34
v_exp_f32 v35, v35
v_exp_f32 v36, v36
v_exp_f32 v37, v37
v_exp_f32 v38, v38
v_exp_f32 v39, v39
s_waitcnt lgkmcnt(2)
v_mfma_f32_32x32x16_bf16 v[48:63], v[104:107], v[8:11], v[80:95]
v_mfma_f32_32x32x16_bf16 v[48:63], v[108:111], v[12:15], v[48:63]
v_exp_f32 v40, v40
v_exp_f32 v41, v41
v_exp_f32 v42, v42
v_exp_f32 v43, v43
v_exp_f32 v44, v44
v_exp_f32 v45, v45
v_exp_f32 v46, v46
v_exp_f32 v47, v47
v_cvt_pk_bf16_f32 v16, v32, v33
v_cvt_pk_bf16_f32 v17, v34, v35
v_cvt_pk_bf16_f32 v18, v36, v37
v_cvt_pk_bf16_f32 v19, v38, v39
v_cvt_pk_bf16_f32 v20, v40, v41
v_cvt_pk_bf16_f32 v21, v42, v43
v_cvt_pk_bf16_f32 v22, v44, v45
v_cvt_pk_bf16_f32 v23, v46, v47
s_nop 1
v_mfma_f32_32x32x16_bf16 v[64:79], v[112:115], v[16:19], v[64:79]
v_mfma_f32_32x32x16_bf16 v[64:79], v[116:119], v[20:23], v[64:79]
v_max3_f32 v7, v48, v49, v50
v_max3_f32 v7, v7, v51, v52
v_max3_f32 v7, v7, v53, v54
v_max3_f32 v7, v7, v55, v56
v_max3_f32 v7, v7, v57, v58
v_max3_f32 v7, v7, v59, v60
v_max3_f32 v7, v7, v61, v62
v_max_f32 v7, v7, v63
v_cmp_gt_f32 vcc, v7, v5
s_cbranch_vccnz aF_rare3
aF_back3:
v_exp_f32 v48, v48
v_exp_f32 v49, v49
v_exp_f32 v50, v50
v_exp_f32 v51, v51
v_exp_f32 v52, v52
v_exp_f32 v53, v53
v_exp_f32 v54, v54
v_exp_f32 v55, v55
v_exp_f32 v56, v56
v_exp_f32 v57, v57
v_exp_f32 v58, v58
v_exp_f32 v59, v59
v_exp_f32 v60, v60
v_exp_f32 v61, v61
v_exp_f32 v62, v62
v_exp_f32 v63, v63
v_cvt_pk_bf16_f32 v16, v48, v49
v_cvt_pk_bf16_f32 v17, v50, v51
v_cvt_pk_bf16_f32 v18, v52, v53
v_cvt_pk_bf16_f32 v19, v54, v55
v_cvt_pk_bf16_f32 v20, v56, v57
v_cvt_pk_bf16_f32 v21, v58, v59
v_cvt_pk_bf16_f32 v22, v60, v61
v_cvt_pk_bf16_f32 v23, v62, v63
s_nop 1
s_waitcnt lgkmcnt(0)
v_mfma_f32_32x32x16_bf16 v[64:79], v[120:123], v[16:19], v[64:79]
v_mfma_f32_32x32x16_bf16 v[64:79], v[124:127], v[20:23], v[64:79]
s_nop 15
s_nop 3
v_mov_b32 v24, v76
v_mov_b32 v25, v76
s_nop 1
v_permlane32_swap_b32 v24, v25
v_rcp_f32 v25, v25
s_nop 0
s_and_b32 s23, s3, 15
s_lshr_b32 s24, s3, 4
s_mul_i32 s24, s24, 1835008
s_mul_i32 s23, s23, 56
s_add_u32 s24, s24, s23
s_add_u32 s24, s24, 12582912
s_add_u32 s26, s20, s24
s_addc_u32 s27, s21, 0
s_lshl_b32 s25, s6, 5
v_and_b32 v26, 31, v2
v_add_u32 v26, s25, v26
v_mul_u32_u24 v26, 896, v26
v_lshrrev_b32 v27, 5, v2
v_lshlrev_b32 v27, 3, v27
v_add_u32 v26, v26, v27
v_mul_f32 v64, v25, v64
v_mul_f32 v65, v25, v65
v_mul_f32 v66, v25, v66
v_mul_f32 v67, v25, v67
v_cvt_pk_bf16_f32 v28, v64, v65
v_cvt_pk_bf16_f32 v29, v66, v67
global_store_dwordx2 v26, v[28:29], s[26:27] offset:0
s_nop 1
v_mul_f32 v68, v25, v68
v_mul_f32 v69, v25, v69
v_mul_f32 v70, v25, v70
v_mul_f32 v71, v25, v71
v_cvt_pk_bf16_f32 v28, v68, v69
v_cvt_pk_bf16_f32 v29, v70, v71
global_store_dwordx2 v26, v[28:29], s[26:27] offset:16
s_nop 1
v_mul_f32 v72, v25, v72
v_mul_f32 v73, v25, v73
v_mul_f32 v74, v25, v74
v_mul_f32 v75, v25, v75
v_cvt_pk_bf16_f32 v28, v72, v73
v_cvt_pk_bf16_f32 v29, v74, v75
global_store_dwordx2 v26, v[28:29], s[26:27] offset:32
s_nop 1
v_mul_f32 v76, v25, v76
v_mul_f32 v77, v25, v77
v_mul_f32 v78, v25, v78
v_mul_f32 v79, v25, v79
v_cvt_pk_bf16_f32 v28, v76, v77
v_cvt_pk_bf16_f32 v29, v78, v79
s_mov_b64 exec, 0xffffffff
global_store_dwordx2 v26, v[28:29], s[26:27] offset:48
s_nop 1
attn_kernel_end:
s_endpgm
aL_rare0:
s_nop 15
v_mov_b32 v24, v7
v_mov_b32 v25, v7
s_nop 1
v_permlane32_swap_b32 v24, v25
v_max_f32 v24, v24, v25
v_max_f32 v24, v24, v6
v_mov_b32 v6, 0
v_mov_b32 v5, 0x41000000
v_max_f32 v25, 0, v24
v_exp_f32 v25, -v25
s_nop 0
v_mul_f32 v64, v25, v64
v_sub_f32 v32, v32, v24
v_sub_f32 v80, v80, v24
v_mul_f32 v65, v25, v65
v_sub_f32 v33, v33, v24
v_sub_f32 v81, v81, v24
v_mul_f32 v66, v25, v66
v_sub_f32 v34, v34, v24
v_sub_f32 v82, v82, v24
v_mul_f32 v67, v25, v67
v_sub_f32 v35, v35, v24
v_sub_f32 v83, v83, v24
v_mul_f32 v68, v25, v68
v_sub_f32 v36, v36, v24
v_sub_f32 v84, v84, v24
v_mul_f32 v69, v25, v69
v_sub_f32 v37, v37, v24
v_sub_f32 v85, v85, v24
v_mul_f32 v70, v25, v70
v_sub_f32 v38, v38, v24
v_sub_f32 v86, v86, v24
v_mul_f32 v71, v25, v71
v_sub_f32 v39, v39, v24
v_sub_f32 v87, v87, v24
v_mul_f32 v72, v25, v72
v_sub_f32 v40, v40, v24
v_sub_f32 v88, v88, v24
v_mul_f32 v73, v25, v73
v_sub_f32 v41, v41, v24
v_sub_f32 v89, v89, v24
v_mul_f32 v74, v25, v74
v_sub_f32 v42, v42, v24
v_sub_f32 v90, v90, v24
v_mul_f32 v75, v25, v75
v_sub_f32 v43, v43, v24
v_sub_f32 v91, v91, v24
v_mul_f32 v76, v25, v76
v_sub_f32 v44, v44, v24
v_sub_f32 v92, v92, v24
v_mul_f32 v77, v25, v77
v_sub_f32 v45, v45, v24
v_sub_f32 v93, v93, v24
v_mul_f32 v78, v25, v78
v_sub_f32 v46, v46, v24
v_sub_f32 v94, v94, v24
v_mul_f32 v79, v25, v79
v_sub_f32 v47, v47, v24
v_sub_f32 v95, v95, v24
s_nop 1
s_branch aL_back0
aL_rare1:
s_nop 15
v_mov_b32 v24, v7
v_mov_b32 v25, v7
s_nop 1
v_permlane32_swap_b32 v24, v25
v_max_f32 v24, v24, v25
v_max_f32 v24, v24, v6
v_mov_b32 v6, 0
v_mov_b32 v5, 0x41000000
v_max_f32 v25, 0, v24
v_exp_f32 v25, -v25
s_nop 0
v_mul_f32 v64, v25, v64
v_sub_f32 v48, v48, v24
v_sub_f32 v80, v80, v24
v_mul_f32 v65, v25, v65
v_sub_f32 v49, v49, v24
v_sub_f32 v81, v81, v24
v_mul_f32 v66, v25, v66
v_sub_f32 v50, v50, v24
v_sub_f32 v82, v82, v24
v_mul_f32 v67, v25, v67
v_sub_f32 v51, v51, v24
v_sub_f32 v83, v83, v24
v_mul_f32 v68, v25, v68
v_sub_f32 v52, v52, v24
v_sub_f32 v84, v84, v24
v_mul_f32 v69, v25, v69
v_sub_f32 v53, v53, v24
v_sub_f32 v85, v85, v24
v_mul_f32 v70, v25, v70
v_sub_f32 v54, v54, v24
v_sub_f32 v86, v86, v24
v_mul_f32 v71, v25, v71
v_sub_f32 v55, v55, v24
v_sub_f32 v87, v87, v24
v_mul_f32 v72, v25, v72
v_sub_f32 v56, v56, v24
v_sub_f32 v88, v88, v24
v_mul_f32 v73, v25, v73
v_sub_f32 v57, v57, v24
v_sub_f32 v89, v89, v24
v_mul_f32 v74, v25, v74
v_sub_f32 v58, v58, v24
v_sub_f32 v90, v90, v24
v_mul_f32 v75, v25, v75
v_sub_f32 v59, v59, v24
v_sub_f32 v91, v91, v24
v_mul_f32 v76, v25, v76
v_sub_f32 v60, v60, v24
v_sub_f32 v92, v92, v24
v_mul_f32 v77, v25, v77
v_sub_f32 v61, v61, v24
v_sub_f32 v93, v93, v24
v_mul_f32 v78, v25, v78
v_sub_f32 v62, v62, v24
v_sub_f32 v94, v94, v24
v_mul_f32 v79, v25, v79
v_sub_f32 v63, v63, v24
v_sub_f32 v95, v95, v24
s_nop 1
s_branch aL_back1
aL_rare2:
s_nop 15
v_mov_b32 v24, v7
v_mov_b32 v25, v7
s_nop 1
v_permlane32_swap_b32 v24, v25
v_max_f32 v24, v24, v25
v_max_f32 v24, v24, v6
v_mov_b32 v6, 0
v_mov_b32 v5, 0x41000000
v_max_f32 v25, 0, v24
v_exp_f32 v25, -v25
s_nop 0
v_mul_f32 v64, v25, v64
v_sub_f32 v32, v32, v24
v_sub_f32 v80, v80, v24
v_mul_f32 v65, v25, v65
v_sub_f32 v33, v33, v24
v_sub_f32 v81, v81, v24
v_mul_f32 v66, v25, v66
v_sub_f32 v34, v34, v24
v_sub_f32 v82, v82, v24
v_mul_f32 v67, v25, v67
v_sub_f32 v35, v35, v24
v_sub_f32 v83, v83, v24
v_mul_f32 v68, v25, v68
v_sub_f32 v36, v36, v24
v_sub_f32 v84, v84, v24
v_mul_f32 v69, v25, v69
v_sub_f32 v37, v37, v24
v_sub_f32 v85, v85, v24
v_mul_f32 v70, v25, v70
v_sub_f32 v38, v38, v24
v_sub_f32 v86, v86, v24
v_mul_f32 v71, v25, v71
v_sub_f32 v39, v39, v24
v_sub_f32 v87, v87, v24
v_mul_f32 v72, v25, v72
v_sub_f32 v40, v40, v24
v_sub_f32 v88, v88, v24
v_mul_f32 v73, v25, v73
v_sub_f32 v41, v41, v24
v_sub_f32 v89, v89, v24
v_mul_f32 v74, v25, v74
v_sub_f32 v42, v42, v24
v_sub_f32 v90, v90, v24
v_mul_f32 v75, v25, v75
v_sub_f32 v43, v43, v24
v_sub_f32 v91, v91, v24
v_mul_f32 v76, v25, v76
v_sub_f32 v44, v44, v24
v_sub_f32 v92, v92, v24
v_mul_f32 v77, v25, v77
v_sub_f32 v45, v45, v24
v_sub_f32 v93, v93, v24
v_mul_f32 v78, v25, v78
v_sub_f32 v46, v46, v24
v_sub_f32 v94, v94, v24
v_mul_f32 v79, v25, v79
v_sub_f32 v47, v47, v24
v_sub_f32 v95, v95, v24
s_nop 1
s_branch aL_back2
aL_rare3:
s_nop 15
v_mov_b32 v24, v7
v_mov_b32 v25, v7
s_nop 1
v_permlane32_swap_b32 v24, v25
v_max_f32 v24, v24, v25
v_max_f32 v24, v24, v6
v_mov_b32 v6, 0
v_mov_b32 v5, 0x41000000
v_max_f32 v25, 0, v24
v_exp_f32 v25, -v25
s_nop 0
v_mul_f32 v64, v25, v64
v_sub_f32 v48, v48, v24
v_sub_f32 v80, v80, v24
v_mul_f32 v65, v25, v65
v_sub_f32 v49, v49, v24
v_sub_f32 v81, v81, v24
v_mul_f32 v66, v25, v66
v_sub_f32 v50, v50, v24
v_sub_f32 v82, v82, v24
v_mul_f32 v67, v25, v67
v_sub_f32 v51, v51, v24
v_sub_f32 v83, v83, v24
v_mul_f32 v68, v25, v68
v_sub_f32 v52, v52, v24
v_sub_f32 v84, v84, v24
v_mul_f32 v69, v25, v69
v_sub_f32 v53, v53, v24
v_sub_f32 v85, v85, v24
v_mul_f32 v70, v25, v70
v_sub_f32 v54, v54, v24
v_sub_f32 v86, v86, v24
v_mul_f32 v71, v25, v71
v_sub_f32 v55, v55, v24
v_sub_f32 v87, v87, v24
v_mul_f32 v72, v25, v72
v_sub_f32 v56, v56, v24
v_sub_f32 v88, v88, v24
v_mul_f32 v73, v25, v73
v_sub_f32 v57, v57, v24
v_sub_f32 v89, v89, v24
v_mul_f32 v74, v25, v74
v_sub_f32 v58, v58, v24
v_sub_f32 v90, v90, v24
v_mul_f32 v75, v25, v75
v_sub_f32 v59, v59, v24
v_sub_f32 v91, v91, v24
v_mul_f32 v76, v25, v76
v_sub_f32 v60, v60, v24
v_sub_f32 v92, v92, v24
v_mul_f32 v77, v25, v77
v_sub_f32 v61, v61, v24
v_sub_f32 v93, v93, v24
v_mul_f32 v78, v25, v78
v_sub_f32 v62, v62, v24
v_sub_f32 v94, v94, v24
v_mul_f32 v79, v25, v79
v_sub_f32 v63, v63, v24
v_sub_f32 v95, v95, v24
s_nop 1
s_branch aL_back3
aF_rare0:
s_nop 15
v_mov_b32 v24, v7
v_mov_b32 v25, v7
s_nop 1
v_permlane32_swap_b32 v24, v25
v_max_f32 v24, v24, v25
v_max_f32 v24, v24, v6
v_mov_b32 v6, 0
v_mov_b32 v5, 0x41000000
v_max_f32 v25, 0, v24
v_exp_f32 v25, -v25
s_nop 0
v_mul_f32 v64, v25, v64
v_sub_f32 v32, v32, v24
v_sub_f32 v80, v80, v24
v_mul_f32 v65, v25, v65
v_sub_f32 v33, v33, v24
v_sub_f32 v81, v81, v24
v_mul_f32 v66, v25, v66
v_sub_f32 v34, v34, v24
v_sub_f32 v82, v82, v24
v_mul_f32 v67, v25, v67
v_sub_f32 v35, v35, v24
v_sub_f32 v83, v83, v24
v_mul_f32 v68, v25, v68
v_sub_f32 v36, v36, v24
v_sub_f32 v84, v84, v24
v_mul_f32 v69, v25, v69
v_sub_f32 v37, v37, v24
v_sub_f32 v85, v85, v24
v_mul_f32 v70, v25, v70
v_sub_f32 v38, v38, v24
v_sub_f32 v86, v86, v24
v_mul_f32 v71, v25, v71
v_sub_f32 v39, v39, v24
v_sub_f32 v87, v87, v24
v_mul_f32 v72, v25, v72
v_sub_f32 v40, v40, v24
v_sub_f32 v88, v88, v24
v_mul_f32 v73, v25, v73
v_sub_f32 v41, v41, v24
v_sub_f32 v89, v89, v24
v_mul_f32 v74, v25, v74
v_sub_f32 v42, v42, v24
v_sub_f32 v90, v90, v24
v_mul_f32 v75, v25, v75
v_sub_f32 v43, v43, v24
v_sub_f32 v91, v91, v24
v_mul_f32 v76, v25, v76
v_sub_f32 v44, v44, v24
v_sub_f32 v92, v92, v24
v_mul_f32 v77, v25, v77
v_sub_f32 v45, v45, v24
v_sub_f32 v93, v93, v24
v_mul_f32 v78, v25, v78
v_sub_f32 v46, v46, v24
v_sub_f32 v94, v94, v24
v_mul_f32 v79, v25, v79
v_sub_f32 v47, v47, v24
v_sub_f32 v95, v95, v24
s_nop 1
s_branch aF_back0
aF_rare1:
s_nop 15
v_mov_b32 v24, v7
v_mov_b32 v25, v7
s_nop 1
v_permlane32_swap_b32 v24, v25
v_max_f32 v24, v24, v25
v_max_f32 v24, v24, v6
v_mov_b32 v6, 0
v_mov_b32 v5, 0x41000000
v_max_f32 v25, 0, v24
v_exp_f32 v25, -v25
s_nop 0
v_mul_f32 v64, v25, v64
v_sub_f32 v48, v48, v24
v_sub_f32 v80, v80, v24
v_mul_f32 v65, v25, v65
v_sub_f32 v49, v49, v24
v_sub_f32 v81, v81, v24
v_mul_f32 v66, v25, v66
v_sub_f32 v50, v50, v24
v_sub_f32 v82, v82, v24
v_mul_f32 v67, v25, v67
v_sub_f32 v51, v51, v24
v_sub_f32 v83, v83, v24
v_mul_f32 v68, v25, v68
v_sub_f32 v52, v52, v24
v_sub_f32 v84, v84, v24
v_mul_f32 v69, v25, v69
v_sub_f32 v53, v53, v24
v_sub_f32 v85, v85, v24
v_mul_f32 v70, v25, v70
v_sub_f32 v54, v54, v24
v_sub_f32 v86, v86, v24
v_mul_f32 v71, v25, v71
v_sub_f32 v55, v55, v24
v_sub_f32 v87, v87, v24
v_mul_f32 v72, v25, v72
v_sub_f32 v56, v56, v24
v_sub_f32 v88, v88, v24
v_mul_f32 v73, v25, v73
v_sub_f32 v57, v57, v24
v_sub_f32 v89, v89, v24
v_mul_f32 v74, v25, v74
v_sub_f32 v58, v58, v24
v_sub_f32 v90, v90, v24
v_mul_f32 v75, v25, v75
v_sub_f32 v59, v59, v24
v_sub_f32 v91, v91, v24
v_mul_f32 v76, v25, v76
v_sub_f32 v60, v60, v24
v_sub_f32 v92, v92, v24
v_mul_f32 v77, v25, v77
v_sub_f32 v61, v61, v24
v_sub_f32 v93, v93, v24
v_mul_f32 v78, v25, v78
v_sub_f32 v62, v62, v24
v_sub_f32 v94, v94, v24
v_mul_f32 v79, v25, v79
v_sub_f32 v63, v63, v24
v_sub_f32 v95, v95, v24
s_nop 1
s_branch aF_back1
aF_rare2:
s_nop 15
v_mov_b32 v24, v7
v_mov_b32 v25, v7
s_nop 1
v_permlane32_swap_b32 v24, v25
v_max_f32 v24, v24, v25
v_max_f32 v24, v24, v6
v_mov_b32 v6, 0
v_mov_b32 v5, 0x41000000
v_max_f32 v25, 0, v24
v_exp_f32 v25, -v25
s_nop 0
v_mul_f32 v64, v25, v64
v_sub_f32 v32, v32, v24
v_sub_f32 v80, v80, v24
v_mul_f32 v65, v25, v65
v_sub_f32 v33, v33, v24
v_sub_f32 v81, v81, v24
v_mul_f32 v66, v25, v66
v_sub_f32 v34, v34, v24
v_sub_f32 v82, v82, v24
v_mul_f32 v67, v25, v67
v_sub_f32 v35, v35, v24
v_sub_f32 v83, v83, v24
v_mul_f32 v68, v25, v68
v_sub_f32 v36, v36, v24
v_sub_f32 v84, v84, v24
v_mul_f32 v69, v25, v69
v_sub_f32 v37, v37, v24
v_sub_f32 v85, v85, v24
v_mul_f32 v70, v25, v70
v_sub_f32 v38, v38, v24
v_sub_f32 v86, v86, v24
v_mul_f32 v71, v25, v71
v_sub_f32 v39, v39, v24
v_sub_f32 v87, v87, v24
v_mul_f32 v72, v25, v72
v_sub_f32 v40, v40, v24
v_sub_f32 v88, v88, v24
v_mul_f32 v73, v25, v73
v_sub_f32 v41, v41, v24
v_sub_f32 v89, v89, v24
v_mul_f32 v74, v25, v74
v_sub_f32 v42, v42, v24
v_sub_f32 v90, v90, v24
v_mul_f32 v75, v25, v75
v_sub_f32 v43, v43, v24
v_sub_f32 v91, v91, v24
v_mul_f32 v76, v25, v76
v_sub_f32 v44, v44, v24
v_sub_f32 v92, v92, v24
v_mul_f32 v77, v25, v77
v_sub_f32 v45, v45, v24
v_sub_f32 v93, v93, v24
v_mul_f32 v78, v25, v78
v_sub_f32 v46, v46, v24
v_sub_f32 v94, v94, v24
v_mul_f32 v79, v25, v79
v_sub_f32 v47, v47, v24
v_sub_f32 v95, v95, v24
s_nop 1
s_branch aF_back2
aF_rare3:
s_nop 15
v_mov_b32 v24, v7
v_mov_b32 v25, v7
s_nop 1
v_permlane32_swap_b32 v24, v25
v_max_f32 v24, v24, v25
v_max_f32 v24, v24, v6
v_mov_b32 v6, 0
v_mov_b32 v5, 0x41000000
v_max_f32 v25, 0, v24
v_exp_f32 v25, -v25
s_nop 0
v_mul_f32 v64, v25, v64
v_sub_f32 v48, v48, v24
v_sub_f32 v80, v80, v24
v_mul_f32 v65, v25, v65
v_sub_f32 v49, v49, v24
v_sub_f32 v81, v81, v24
v_mul_f32 v66, v25, v66
v_sub_f32 v50, v50, v24
v_sub_f32 v82, v82, v24
v_mul_f32 v67, v25, v67
v_sub_f32 v51, v51, v24
v_sub_f32 v83, v83, v24
v_mul_f32 v68, v25, v68
v_sub_f32 v52, v52, v24
v_sub_f32 v84, v84, v24
v_mul_f32 v69, v25, v69
v_sub_f32 v53, v53, v24
v_sub_f32 v85, v85, v24
v_mul_f32 v70, v25, v70
v_sub_f32 v54, v54, v24
v_sub_f32 v86, v86, v24
v_mul_f32 v71, v25, v71
v_sub_f32 v55, v55, v24
v_sub_f32 v87, v87, v24
v_mul_f32 v72, v25, v72
v_sub_f32 v56, v56, v24
v_sub_f32 v88, v88, v24
v_mul_f32 v73, v25, v73
v_sub_f32 v57, v57, v24
v_sub_f32 v89, v89, v24
v_mul_f32 v74, v25, v74
v_sub_f32 v58, v58, v24
v_sub_f32 v90, v90, v24
v_mul_f32 v75, v25, v75
v_sub_f32 v59, v59, v24
v_sub_f32 v91, v91, v24
v_mul_f32 v76, v25, v76
v_sub_f32 v60, v60, v24
v_sub_f32 v92, v92, v24
v_mul_f32 v77, v25, v77
v_sub_f32 v61, v61, v24
v_sub_f32 v93, v93, v24
v_mul_f32 v78, v25, v78
v_sub_f32 v62, v62, v24
v_sub_f32 v94, v94, v24
v_mul_f32 v79, v25, v79
v_sub_f32 v63, v63, v24
v_sub_f32 v95, v95, v24
s_nop 1
s_branch aF_back3
.globl oproj_kernel
.p2align 8
.type oproj_kernel,@function
oproj_kernel:
s_cmp_ge_u32 s2, 224
s_cbranch_scc1 oproj_kernel_end
s_load_dwordx8 s[4:11], s[0:1], 0
s_load_dwordx8 s[12:19], s[0:1], 32
s_load_dwordx2 s[20:21], s[0:1], 64
s_mov_b32 s22, 613566757
s_mul_hi_u32 s23, s2, s22
s_mul_i32 s24, s23, 7
s_sub_u32 s24, s2, s24
s_and_b32 s25, s23, 15
s_lshr_b32 s26, s23, 4
v_lshrrev_b32 v1, 6, v0
v_and_b32 v2, 63, v0
s_nop 0
v_readfirstlane_b32 s27, v1
s_waitcnt lgkmcnt(0)
s_cmp_eq_u32 s26, 0
s_cselect_b32 s30, s8, s14
s_cselect_b32 s31, s9, s15
s_mul_i32 s32, s26, 1835008
s_add_u32 s32, s32, 12582912
s_add_u32 s28, s20, s32
s_addc_u32 s29, s21, 0
s_lshl_b32 s33, s24, 6
s_mul_i32 s34, s27, 112
v_lshrrev_b32 v3, 3, v2
v_add_u32 v3, s34, v3
v_and_b32 v4, 7, v2
s_mov_b32 s35, 896
v_mul_lo_u32 v5, v3, s35
s_lshl_b32 s36, s33, 1
v_lshlrev_b32 v6, 4, v4
v_add3_u32 v5, v5, v6, s36
v_lshrrev_b32 v6, 2, v4
v_mul_u32_u24 v6, 28672, v6
v_lshlrev_b32 v7, 6, v3
v_and_b32 v8, 3, v2
v_lshlrev_b32 v8, 4, v8
v_add3_u32 v6, v6, v7, v8
global_load_dwordx4 v[128:131], v5, s[30:31]
v_add_u32 v5, 7168, v5
global_load_dwordx4 v[132:135], v5, s[30:31]
v_add_u32 v5, 7168, v5
global_load_dwordx4 v[136:139], v5, s[30:31]
v_add_u32 v5, 7168, v5
global_load_dwordx4 v[140:143], v5, s[30:31]
v_add_u32 v5, 7168, v5
global_load_dwordx4 v[144:147], v5, s[30:31]
v_add_u32 v5, 7168, v5
global_load_dwordx4 v[148:151], v5, s[30:31]
v_add_u32 v5, 7168, v5
global_load_dwordx4 v[152:155], v5, s[30:31]
v_add_u32 v5, 7168, v5
global_load_dwordx4 v[156:159], v5, s[30:31]
v_add_u32 v5, 7168, v5
global_load_dwordx4 v[160:163], v5, s[30:31]
v_add_u32 v5, 7168, v5
global_load_dwordx4 v[164:167], v5, s[30:31]
v_add_u32 v5, 7168, v5
global_load_dwordx4 v[168:171], v5, s[30:31]
v_add_u32 v5, 7168, v5
global_load_dwordx4 v[172:175], v5, s[30:31]
v_add_u32 v5, 7168, v5
global_load_dwordx4 v[176:179], v5, s[30:31]
v_add_u32 v5, 7168, v5
global_load_dwordx4 v[180:183], v5, s[30:31]
s_lshl_b32 s37, s25, 7
s_lshl_b32 s38, s27, 5
s_add_u32 s37, s37, s38
v_and_b32 v9, 31, v2
v_add_u32 v10, s37, v9
v_mul_u32_u24 v10, 896, v10
v_lshrrev_b32 v11, 5, v2
v_lshlrev_b32 v12, 4, v11
v_add_u32 v10, v10, v12
global_load_dwordx4 v[16:19], v10, s[28:29] offset:0
global_load_dwordx4 v[20:23], v10, s[28:29] offset:32
global_load_dwordx4 v[24:27], v10, s[28:29] offset:64
global_load_dwordx4 v[28:31], v10, s[28:29] offset:96
global_load_dwordx4 v[32:35], v10, s[28:29] offset:128
global_load_dwordx4 v[36:39], v10, s[28:29] offset:160
global_load_dwordx4 v[40:43], v10, s[28:29] offset:192
global_load_dwordx4 v[44:47], v10, s[28:29] offset:224
global_load_dwordx4 v[48:51], v10, s[28:29] offset:256
global_load_dwordx4 v[52:55], v10, s[28:29] offset:288
global_load_dwordx4 v[56:59], v10, s[28:29] offset:320
global_load_dwordx4 v[60:63], v10, s[28:29] offset:352
global_load_dwordx4 v[64:67], v10, s[28:29] offset:384
global_load_dwordx4 v[68:71], v10, s[28:29] offset:416
global_load_dwordx4 v[72:75], v10, s[28:29] offset:448
global_load_dwordx4 v[76:79], v10, s[28:29] offset:480
global_load_dwordx4 v[80:83], v10, s[28:29] offset:512
global_load_dwordx4 v[84:87], v10, s[28:29] offset:544
global_load_dwordx4 v[88:91], v10, s[28:29] offset:576
global_load_dwordx4 v[92:95], v10, s[28:29] offset:608
global_load_dwordx4 v[96:99], v10, s[28:29] offset:640
global_load_dwordx4 v[100:103], v10, s[28:29] offset:672
global_load_dwordx4 v[104:107], v10, s[28:29] offset:704
global_load_dwordx4 v[108:111], v10, s[28:29] offset:736
global_load_dwordx4 v[112:115], v10, s[28:29] offset:768
global_load_dwordx4 v[116:119], v10, s[28:29] offset:800
global_load_dwordx4 v[120:123], v10, s[28:29] offset:832
global_load_dwordx4 v[124:127], v10, s[28:29] offset:864
s_waitcnt vmcnt(28)
ds_write_b128 v6, v[128:131] offset:0
ds_write_b128 v6, v[132:135] offset:512
ds_write_b128 v6, v[136:139] offset:1024
ds_write_b128 v6, v[140:143] offset:1536
ds_write_b128 v6, v[144:147] offset:2048
ds_write_b128 v6, v[148:151] offset:2560
ds_write_b128 v6, v[152:155] offset:3072
ds_write_b128 v6, v[156:159] offset:3584
ds_write_b128 v6, v[160:163] offset:4096
ds_write_b128 v6, v[164:167] offset:4608
ds_write_b128 v6, v[168:171] offset:5120
ds_write_b128 v6, v[172:175] offset:5632
ds_write_b128 v6, v[176:179] offset:6144
ds_write_b128 v6, v[180:183] offset:6656
v_lshrrev_b32 v13, 4, v2
v_lshrrev_b32 v14, 1, v13
v_lshlrev_b32 v14, 9, v14
v_and_b32 v15, 15, v2
v_lshrrev_b32 v15, 2, v15
v_lshlrev_b32 v15, 6, v15
v_add_u32 v14, v14, v15
v_and_b32 v13, 1, v13
v_lshlrev_b32 v13, 5, v13
v_and_b32 v15, 3, v2
v_lshlrev_b32 v15, 3, v15
v_add3_u32 v14, v14, v13, v15
s_waitcnt lgkmcnt(0)
s_barrier
v_mov_b32 v192, 0
v_mov_b32 v193, 0
v_mov_b32 v194, 0
v_mov_b32 v195, 0
v_mov_b32 v196, 0
v_mov_b32 v197, 0
v_mov_b32 v198, 0
v_mov_b32 v199, 0
v_mov_b32 v200, 0
v_mov_b32 v201, 0
v_mov_b32 v202, 0
v_mov_b32 v203, 0
v_mov_b32 v204, 0
v_mov_b32 v205, 0
v_mov_b32 v206, 0
v_mov_b32 v207, 0
v_mov_b32 v208, 0
v_mov_b32 v209, 0
v_mov_b32 v210, 0
v_mov_b32 v211, 0
v_mov_b32 v212, 0
v_mov_b32 v213, 0
v_mov_b32 v214, 0
v_mov_b32 v215, 0
v_mov_b32 v216, 0
v_mov_b32 v217, 0
v_mov_b32 v218, 0
v_mov_b32 v219, 0
v_mov_b32 v220, 0
v_mov_b32 v221, 0
v_mov_b32 v222, 0
v_mov_b32 v223, 0
ds_read_b64_tr_b16 v[224:225], v14 offset:0
ds_read_b64_tr_b16 v[226:227], v14 offset:256
ds_read_b64_tr_b16 v[228:229], v14 offset:28672
ds_read_b64_tr_b16 v[230:231], v14 offset:28928
ds_read_b64_tr_b16 v[240:241], v14 offset:1024
ds_read_b64_tr_b16 v[242:243], v14 offset:1280
ds_read_b64_tr_b16 v[244:245], v14 offset:29696
ds_read_b64_tr_b16 v[246:247], v14 offset:29952
s_waitcnt vmcnt(27) lgkmcnt(4)
v_mfma_f32_32x32x16_bf16 v[192:207], v[224:227], v[16:19], v[192:207]
v_mfma_f32_32x32x16_bf16 v[208:223], v[228:231], v[16:19], v[208:223]
ds_read_b64_tr_b16 v[224:225], v14 offset:2048
ds_read_b64_tr_b16 v[226:227], v14 offset:2304
ds_read_b64_tr_b16 v[228:229], v14 offset:30720
ds_read_b64_tr_b16 v[230:231], v14 offset:30976
s_waitcnt vmcnt(26) lgkmcnt(4)
v_mfma_f32_32x32x16_bf16 v[192:207], v[240:243], v[20:23], v[192:207]
v_mfma_f32_32x32x16_bf16 v[208:223], v[244:247], v[20:23], v[208:223]
ds_read_b64_tr_b16 v[240:241], v14 offset:3072
ds_read_b64_tr_b16 v[242:243], v14 offset:3328
ds_read_b64_tr_b16 v[244:245], v14 offset:31744
ds_read_b64_tr_b16 v[246:247], v14 offset:32000
s_waitcnt vmcnt(25) lgkmcnt(4)
v_mfma_f32_32x32x16_bf16 v[192:207], v[224:227], v[24:27], v[192:207]
v_mfma_f32_32x32x16_bf16 v[208:223], v[228:231], v[24:27], v[208:223]
ds_read_b64_tr_b16 v[224:225], v14 offset:4096
ds_read_b64_tr_b16 v[226:227], v14 offset:4352
ds_read_b64_tr_b16 v[228:229], v14 offset:32768
ds_read_b64_tr_b16 v[230:231], v14 offset:33024
s_waitcnt vmcnt(24) lgkmcnt(4)
v_mfma_f32_32x32x16_bf16 v[192:207], v[240:243], v[28:31], v[192:207]
v_mfma_f32_32x32x16_bf16 v[208:223], v[244:247], v[28:31], v[208:223]
ds_read_b64_tr_b16 v[240:241], v14 offset:5120
ds_read_b64_tr_b16 v[242:243], v14 offset:5376
ds_read_b64_tr_b16 v[244:245], v14 offset:33792
ds_read_b64_tr_b16 v[246:247], v14 offset:34048
s_waitcnt vmcnt(23) lgkmcnt(4)
v_mfma_f32_32x32x16_bf16 v[192:207], v[224:227], v[32:35], v[192:207]
v_mfma_f32_32x32x16_bf16 v[208:223], v[228:231], v[32:35], v[208:223]
ds_read_b64_tr_b16 v[224:225], v14 offset:6144
ds_read_b64_tr_b16 v[226:227], v14 offset:6400
ds_read_b64_tr_b16 v[228:229], v14 offset:34816
ds_read_b64_tr_b16 v[230:231], v14 offset:35072
s_waitcnt vmcnt(22) lgkmcnt(4)
v_mfma_f32_32x32x16_bf16 v[192:207], v[240:243], v[36:39], v[192:207]
v_mfma_f32_32x32x16_bf16 v[208:223], v[244:247], v[36:39], v[208:223]
ds_read_b64_tr_b16 v[240:241], v14 offset:7168
ds_read_b64_tr_b16 v[242:243], v14 offset:7424
ds_read_b64_tr_b16 v[244:245], v14 offset:35840
ds_read_b64_tr_b16 v[246:247], v14 offset:36096
s_waitcnt vmcnt(21) lgkmcnt(4)
v_mfma_f32_32x32x16_bf16 v[192:207], v[224:227], v[40:43], v[192:207]
v_mfma_f32_32x32x16_bf16 v[208:223], v[228:231], v[40:43], v[208:223]
ds_read_b64_tr_b16 v[224:225], v14 offset:8192
ds_read_b64_tr_b16 v[226:227], v14 offset:8448
ds_read_b64_tr_b16 v[228:229], v14 offset:36864
ds_read_b64_tr_b16 v[230:231], v14 offset:37120
s_waitcnt vmcnt(20) lgkmcnt(4)
v_mfma_f32_32x32x16_bf16 v[192:207], v[240:243], v[44:47], v[192:207]
v_mfma_f32_32x32x16_bf16 v[208:223], v[244:247], v[44:47], v[208:223]
ds_read_b64_tr_b16 v[240:241], v14 offset:9216
ds_read_b64_tr_b16 v[242:243], v14 offset:9472
ds_read_b64_tr_b16 v[244:245], v14 offset:37888
ds_read_b64_tr_b16 v[246:247], v14 offset:38144
s_waitcnt vmcnt(19) lgkmcnt(4)
v_mfma_f32_32x32x16_bf16 v[192:207], v[224:227], v[48:51], v[192:207]
v_mfma_f32_32x32x16_bf16 v[208:223], v[228:231], v[48:51], v[208:223]
ds_read_b64_tr_b16 v[224:225], v14 offset:10240
ds_read_b64_tr_b16 v[226:227], v14 offset:10496
ds_read_b64_tr_b16 v[228:229], v14 offset:38912
ds_read_b64_tr_b16 v[230:231], v14 offset:39168
s_waitcnt vmcnt(18) lgkmcnt(4)
v_mfma_f32_32x32x16_bf16 v[192:207], v[240:243], v[52:55], v[192:207]
v_mfma_f32_32x32x16_bf16 v[208:223], v[244:247], v[52:55], v[208:223]
ds_read_b64_tr_b16 v[240:241], v14 offset:11264
ds_read_b64_tr_b16 v[242:243], v14 offset:11520
ds_read_b64_tr_b16 v[244:245], v14 offset:39936
ds_read_b64_tr_b16 v[246:247], v14 offset:40192
s_waitcnt vmcnt(17) lgkmcnt(4)
v_mfma_f32_32x32x16_bf16 v[192:207], v[224:227], v[56:59], v[192:207]
v_mfma_f32_32x32x16_bf16 v[208:223], v[228:231], v[56:59], v[208:223]
ds_read_b64_tr_b16 v[224:225], v14 offset:12288
ds_read_b64_tr_b16 v[226:227], v14 offset:12544
ds_read_b64_tr_b16 v[228:229], v14 offset:40960
ds_read_b64_tr_b16 v[230:231], v14 offset:41216
s_waitcnt vmcnt(16) lgkmcnt(4)
v_mfma_f32_32x32x16_bf16 v[192:207], v[240:243], v[60:63], v[192:207]
v_mfma_f32_32x32x16_bf16 v[208:223], v[244:247], v[60:63], v[208:223]
ds_read_b64_tr_b16 v[240:241], v14 offset:13312
ds_read_b64_tr_b16 v[242:243], v14 offset:13568
ds_read_b64_tr_b16 v[244:245], v14 offset:41984
ds_read_b64_tr_b16 v[246:247], v14 offset:42240
s_waitcnt vmcnt(15) lgkmcnt(4)
v_mfma_f32_32x32x16_bf16 v[192:207], v[224:227], v[64:67], v[192:207]
v_mfma_f32_32x32x16_bf16 v[208:223], v[228:231], v[64:67], v[208:223]
ds_read_b64_tr_b16 v[224:225], v14 offset:14336
ds_read_b64_tr_b16 v[226:227], v14 offset:14592
ds_read_b64_tr_b16 v[228:229], v14 offset:43008
ds_read_b64_tr_b16 v[230:231], v14 offset:43264
s_waitcnt vmcnt(14) lgkmcnt(4)
v_mfma_f32_32x32x16_bf16 v[192:207], v[240:243], v[68:71], v[192:207]
v_mfma_f32_32x32x16_bf16 v[208:223], v[244:247], v[68:71], v[208:223]
ds_read_b64_tr_b16 v[240:241], v14 offset:15360
ds_read_b64_tr_b16 v[242:243], v14 offset:15616
ds_read_b64_tr_b16 v[244:245], v14 offset:44032
ds_read_b64_tr_b16 v[246:247], v14 offset:44288
s_waitcnt vmcnt(13) lgkmcnt(4)
v_mfma_f32_32x32x16_bf16 v[192:207], v[224:227], v[72:75], v[192:207]
v_mfma_f32_32x32x16_bf16 v[208:223], v[228:231], v[72:75], v[208:223]
ds_read_b64_tr_b16 v[224:225], v14 offset:16384
ds_read_b64_tr_b16 v[226:227], v14 offset:16640
ds_read_b64_tr_b16 v[228:229], v14 offset:45056
ds_read_b64_tr_b16 v[230:231], v14 offset:45312
s_waitcnt vmcnt(12) lgkmcnt(4)
v_mfma_f32_32x32x16_bf16 v[192:207], v[240:243], v[76:79], v[192:207]
v_mfma_f32_32x32x16_bf16 v[208:223], v[244:247], v[76:79], v[208:223]
ds_read_b64_tr_b16 v[240:241], v14 offset:17408
ds_read_b64_tr_b16 v[242:243], v14 offset:17664
ds_read_b64_tr_b16 v[244:245], v14 offset:46080
ds_read_b64_tr_b16 v[246:247], v14 offset:46336
s_waitcnt vmcnt(11) lgkmcnt(4)
v_mfma_f32_32x32x16_bf16 v[192:207], v[224:227], v[80:83], v[192:207]
v_mfma_f32_32x32x16_bf16 v[208:223], v[228:231], v[80:83], v[208:223]
ds_read_b64_tr_b16 v[224:225], v14 offset:18432
ds_read_b64_tr_b16 v[226:227], v14 offset:18688
ds_read_b64_tr_b16 v[228:229], v14 offset:47104
ds_read_b64_tr_b16 v[230:231], v14 offset:47360
s_waitcnt vmcnt(10) lgkmcnt(4)
v_mfma_f32_32x32x16_bf16 v[192:207], v[240:243], v[84:87], v[192:207]
v_mfma_f32_32x32x16_bf16 v[208:223], v[244:247], v[84:87], v[208:223]
ds_read_b64_tr_b16 v[240:241], v14 offset:19456
ds_read_b64_tr_b16 v[242:243], v14 offset:19712
ds_read_b64_tr_b16 v[244:245], v14 offset:48128
ds_read_b64_tr_b16 v[246:247], v14 offset:48384
s_waitcnt vmcnt(9) lgkmcnt(4)
v_mfma_f32_32x32x16_bf16 v[192:207], v[224:227], v[88:91], v[192:207]
v_mfma_f32_32x32x16_bf16 v[208:223], v[228:231], v[88:91], v[208:223]
ds_read_b64_tr_b16 v[224:225], v14 offset:20480
ds_read_b64_tr_b16 v[226:227], v14 offset:20736
ds_read_b64_tr_b16 v[228:229], v14 offset:49152
ds_read_b64_tr_b16 v[230:231], v14 offset:49408
s_waitcnt vmcnt(8) lgkmcnt(4)
v_mfma_f32_32x32x16_bf16 v[192:207], v[240:243], v[92:95], v[192:207]
v_mfma_f32_32x32x16_bf16 v[208:223], v[244:247], v[92:95], v[208:223]
ds_read_b64_tr_b16 v[240:241], v14 offset:21504
ds_read_b64_tr_b16 v[242:243], v14 offset:21760
ds_read_b64_tr_b16 v[244:245], v14 offset:50176
ds_read_b64_tr_b16 v[246:247], v14 offset:50432
s_waitcnt vmcnt(7) lgkmcnt(4)
v_mfma_f32_32x32x16_bf16 v[192:207], v[224:227], v[96:99], v[192:207]
v_mfma_f32_32x32x16_bf16 v[208:223], v[228:231], v[96:99], v[208:223]
ds_read_b64_tr_b16 v[224:225], v14 offset:22528
ds_read_b64_tr_b16 v[226:227], v14 offset:22784
ds_read_b64_tr_b16 v[228:229], v14 offset:51200
ds_read_b64_tr_b16 v[230:231], v14 offset:51456
s_waitcnt vmcnt(6) lgkmcnt(4)
v_mfma_f32_32x32x16_bf16 v[192:207], v[240:243], v[100:103], v[192:207]
v_mfma_f32_32x32x16_bf16 v[208:223], v[244:247], v[100:103], v[208:223]
ds_read_b64_tr_b16 v[240:241], v14 offset:23552
ds_read_b64_tr_b16 v[242:243], v14 offset:23808
ds_read_b64_tr_b16 v[244:245], v14 offset:52224
ds_read_b64_tr_b16 v[246:247], v14 offset:52480
s_waitcnt vmcnt(5) lgkmcnt(4)
v_mfma_f32_32x32x16_bf16 v[192:207], v[224:227], v[104:107], v[192:207]
v_mfma_f32_32x32x16_bf16 v[208:223], v[228:231], v[104:107], v[208:223]
ds_read_b64_tr_b16 v[224:225], v14 offset:24576
ds_read_b64_tr_b16 v[226:227], v14 offset:24832
ds_read_b64_tr_b16 v[228:229], v14 offset:53248
ds_read_b64_tr_b16 v[230:231], v14 offset:53504
s_waitcnt vmcnt(4) lgkmcnt(4)
v_mfma_f32_32x32x16_bf16 v[192:207], v[240:243], v[108:111], v[192:207]
v_mfma_f32_32x32x16_bf16 v[208:223], v[244:247], v[108:111], v[208:223]
ds_read_b64_tr_b16 v[240:241], v14 offset:25600
ds_read_b64_tr_b16 v[242:243], v14 offset:25856
ds_read_b64_tr_b16 v[244:245], v14 offset:54272
ds_read_b64_tr_b16 v[246:247], v14 offset:54528
s_waitcnt vmcnt(3) lgkmcnt(4)
v_mfma_f32_32x32x16_bf16 v[192:207], v[224:227], v[112:115], v[192:207]
v_mfma_f32_32x32x16_bf16 v[208:223], v[228:231], v[112:115], v[208:223]
ds_read_b64_tr_b16 v[224:225], v14 offset:26624
ds_read_b64_tr_b16 v[226:227], v14 offset:26880
ds_read_b64_tr_b16 v[228:229], v14 offset:55296
ds_read_b64_tr_b16 v[230:231], v14 offset:55552
s_waitcnt vmcnt(2) lgkmcnt(4)
v_mfma_f32_32x32x16_bf16 v[192:207], v[240:243], v[116:119], v[192:207]
v_mfma_f32_32x32x16_bf16 v[208:223], v[244:247], v[116:119], v[208:223]
ds_read_b64_tr_b16 v[240:241], v14 offset:27648
ds_read_b64_tr_b16 v[242:243], v14 offset:27904
ds_read_b64_tr_b16 v[244:245], v14 offset:56320
ds_read_b64_tr_b16 v[246:247], v14 offset:56576
s_waitcnt vmcnt(1) lgkmcnt(4)
v_mfma_f32_32x32x16_bf16 v[192:207], v[224:227], v[120:123], v[192:207]
v_mfma_f32_32x32x16_bf16 v[208:223], v[228:231], v[120:123], v[208:223]
s_waitcnt vmcnt(0) lgkmcnt(0)
v_mfma_f32_32x32x16_bf16 v[192:207], v[240:243], v[124:127], v[192:207]
v_mfma_f32_32x32x16_bf16 v[208:223], v[244:247], v[124:127], v[208:223]
s_nop 15
s_nop 3
v_add_u32 v16, s37, v9
v_mul_u32_u24 v16, 1792, v16
s_mul_i32 s39, s26, 896
s_add_u32 s39, s39, s36
v_lshlrev_b32 v17, 3, v11
v_add3_u32 v16, v16, v17, s39
v_cvt_pk_bf16_f32 v20, v192, v193
v_cvt_pk_bf16_f32 v21, v194, v195
global_store_dwordx2 v16, v[20:21], s[16:17] offset:0
s_nop 1
v_cvt_pk_bf16_f32 v20, v196, v197
v_cvt_pk_bf16_f32 v21, v198, v199
global_store_dwordx2 v16, v[20:21], s[16:17] offset:16
s_nop 1
v_cvt_pk_bf16_f32 v20, v200, v201
v_cvt_pk_bf16_f32 v21, v202, v203
global_store_dwordx2 v16, v[20:21], s[16:17] offset:32
s_nop 1
v_cvt_pk_bf16_f32 v20, v204, v205
v_cvt_pk_bf16_f32 v21, v206, v207
global_store_dwordx2 v16, v[20:21], s[16:17] offset:48
s_nop 1
v_cvt_pk_bf16_f32 v20, v208, v209
v_cvt_pk_bf16_f32 v21, v210, v211
global_store_dwordx2 v16, v[20:21], s[16:17] offset:64
s_nop 1
v_cvt_pk_bf16_f32 v20, v212, v213
v_cvt_pk_bf16_f32 v21, v214, v215
global_store_dwordx2 v16, v[20:21], s[16:17] offset:80
s_nop 1
v_cvt_pk_bf16_f32 v20, v216, v217
v_cvt_pk_bf16_f32 v21, v218, v219
global_store_dwordx2 v16, v[20:21], s[16:17] offset:96
s_nop 1
v_cvt_pk_bf16_f32 v20, v220, v221
v_cvt_pk_bf16_f32 v21, v222, v223
global_store_dwordx2 v16, v[20:21], s[16:17] offset:112
s_nop 1
oproj_kernel_end:
s_endpgm
.section .rodata,"a"
.p2align 6
.amdhsa_kernel qkv_kernel
  .amdhsa_next_free_vgpr 256
  .amdhsa_next_free_sgpr 64
  .amdhsa_accum_offset 256
  .amdhsa_group_segment_fixed_size 0
  .amdhsa_kernarg_size 72
  .amdhsa_user_sgpr_count 2
  .amdhsa_user_sgpr_kernarg_segment_ptr 1
  .amdhsa_system_sgpr_workgroup_id_x 1
.end_amdhsa_kernel
.p2align 6
.amdhsa_kernel attn_kernel
  .amdhsa_next_free_vgpr 128
  .amdhsa_next_free_sgpr 64
  .amdhsa_accum_offset 128
  .amdhsa_group_segment_fixed_size 0
  .amdhsa_kernarg_size 72
  .amdhsa_user_sgpr_count 2
  .amdhsa_user_sgpr_kernarg_segment_ptr 1
  .amdhsa_system_sgpr_workgroup_id_x 1
.end_amdhsa_kernel
.p2align 6
.amdhsa_kernel oproj_kernel
  .amdhsa_next_free_vgpr 256
  .amdhsa_next_free_sgpr 64
  .amdhsa_accum_offset 256
  .amdhsa_group_segment_fixed_size 0
  .amdhsa_kernarg_size 72
  .amdhsa_user_sgpr_count 2
  .amdhsa_user_sgpr_kernarg_segment_ptr 1
  .amdhsa_system_sgpr_workgroup_id_x 1
.end_amdhsa_kernel
```
